```python
import torch

def _softmax(x, axis=-1):
    return torch.softmax(x, dim=axis)

def _gelu(x):
    return torch.nn.functional.gelu(x, approximate='tanh')

def _silu(x):
    return torch.nn.functional.silu(x)

def _sigmoid(x):
    return torch.sigmoid(x)

def _layernorm(x, axis=-1, eps=1e-05):
    m = x.mean(dim=axis, keepdim=True)
    v = x.var(dim=axis, keepdim=True, unbiased=False)
    return (x - m) / torch.sqrt(v + eps)

def _scatter_add(tgt, idx, src, axis=0):
    return tgt.clone().index_add_(axis, idx, src)

def _segment_sum(src, seg, n):
    out = torch.zeros((n,) + src.shape[1:], dtype=src.dtype)
    return out.index_add_(0, seg, src)

def _pad(x, pw):
    flat = tuple((v for pair in reversed(pw) for v in pair))
    return torch.nn.functional.pad(x, flat)
kernel_name = 'standalone__ragged_sequences_varlen_flash_attn__ragged'

def setup_inputs():

    _w = lambda a: (lambda t: t.to(torch.bfloat16) if t.is_floating_point() else t)(torch.as_tensor(a))
    cu = torch.tensor([0, 506, 648, 1109, 1416, 1494, 1644, 1941, 2399], dtype=torch.int64)
    T = int(cu[-1])
    Hq, Hkv, D = (16, 8, 192)
    assert Hq % Hkv == 0
    return {'q': _w((lambda *s: torch.randn(*s, dtype=torch.bfloat16) * 0.8)(T, Hq, D)), 'k': _w((lambda *s: torch.randn(*s, dtype=torch.bfloat16) * 0.8)(T, Hkv, D)), 'v': _w((lambda *s: torch.randn(*s, dtype=torch.bfloat16) * 0.05)(T, Hkv, D)), 'cu': _w(cu)}

def reference(q, k, v, cu):
    T, Hq, D = q.shape
    Hkv = k.shape[1]
    rep = Hq // Hkv
    scale = D ** (-0.5)
    outs = []
    for i in range(len(cu) - 1):
        s, e = (int(cu[i]), int(cu[i + 1]))
        L = e - s
        qi = q[s:e].clone()
        ki = (lambda x, n, axis: torch.repeat_interleave(x, n, dim=axis))(k[s:e], rep, axis=1)
        vi = (lambda x, n, axis: torch.repeat_interleave(x, n, dim=axis))(v[s:e], rep, axis=1)
        logits = torch.einsum('qhd,khd->hqk', qi, ki) * scale
        ar = torch.arange(L)
        neg = (lambda x, dt: x.to(dt))(ar[None, :] > ar[:, None], logits.dtype) * -1000000000.0
        p = _softmax(logits + neg[None, :, :], axis=-1)
        outs.append(torch.einsum('hqk,khd->qhd', p, vi))
    return torch.concatenate(outs, axis=0)
```

```asm
; @launch grid=(256,1,1) block=(512,1,1) lds=149504
.amdgcn_target "amdgcn-amd-amdhsa--gfx950"
.text
.globl standalone__ragged_sequences_varlen_flash_attn__ragged_kernel
.p2align 8
.type standalone__ragged_sequences_varlen_flash_attn__ragged_kernel,@function
standalone__ragged_sequences_varlen_flash_attn__ragged_kernel:
  s_load_dwordx8 s[4:11], s[0:1], 0
  s_load_dwordx2 s[12:13], s[0:1], 32
  v_readfirstlane_b32 s32, v0
  s_lshr_b32 s3, s2, 3
  s_and_b32 s33, s2, 7
  s_cmp_ge_u32 s3, 32
  s_cbranch_scc1 L_END
  v_and_b32 v14, 63, v0
  s_lshr_b32 s32, s32, 6
  s_cmp_ge_u32 s32, 4
  s_cbranch_scc1 L_LOADER
  s_cmp_eq_u32 s32, 0
  s_cbranch_scc1 L_COMPUTE
  s_mov_b64 exec, 0
  s_cmp_eq_u32 s32, 2
  s_cbranch_scc1 L_G0
  s_cmp_eq_u32 s32, 3
  s_cbranch_scc1 TAIL_1
  s_cmp_lt_u32 s3, 2
  s_cbranch_scc1 L_SH0
  s_cmp_lt_u32 s3, 5
  s_cbranch_scc1 L_SH1
  s_cmp_lt_u32 s3, 8
  s_cbranch_scc1 L_SH2
  s_cmp_lt_u32 s3, 10
  s_cbranch_scc1 L_SH3
  s_cmp_lt_u32 s3, 11
  s_cbranch_scc1 L_SH4
  s_cmp_lt_u32 s3, 12
  s_cbranch_scc1 L_SH5
  s_cmp_lt_u32 s3, 15
  s_cbranch_scc1 L_SH6
  s_cmp_lt_u32 s3, 17
  s_cbranch_scc1 L_SH7
  s_cmp_lt_u32 s3, 22
  s_cbranch_scc1 L_SH8
  s_cmp_lt_u32 s3, 25
  s_cbranch_scc1 L_SH9
  s_cmp_lt_u32 s3, 26
  s_cbranch_scc1 L_SH10
  s_cmp_lt_u32 s3, 29
  s_cbranch_scc1 L_SH11
  s_branch L_SH12
RETH_R1:
  s_branch TAIL_0
RETH_R2:
  s_cmp_lt_u32 s3, 22
  s_cbranch_scc1 TAIL_0z
  s_branch L_MERGE
RETH_R3:
  s_cmp_lt_u32 s3, 22
  s_cbranch_scc1 L_EG
  s_branch L_MERGE1
RETH_R4:
  s_cmp_lt_u32 s3, 22
  s_cbranch_scc1 FIN_0
RETH_R5:
  s_branch L_EPI
RETH_R6:
  s_branch L_ONE
L_LOADER:
  s_setprio 3
  s_and_b32 m0, s3, 15
  s_mov_b32 s56, 0x6cc0475
  s_mov_b32 s57, 0x120068c
  s_mov_b32 s58, 0x3a801fa
  s_mov_b32 s59, 0x5750588
  s_mov_b32 s60, 0x878c05d6
  s_mov_b32 s61, 0x8b50160
  s_mov_b32 s62, 0x1c003e8
  s_mov_b32 s63, 0x844808f5
  s_mov_b32 s64, 0x8955023a
  s_mov_b32 s65, 0x1e005c8
  s_mov_b32 s66, 0x1800616
  s_mov_b32 s67, 0x40807f5
  s_mov_b32 s68, 0x91504f5
  s_mov_b32 s69, 0x1a0070c
  s_mov_b32 s70, 0x4280835
  s_mov_b32 s71, 0x9350060
  s_and_b32 s45, s3, 16
  s_movrels_b32 s35, s56
  s_sub_u32 s32, s32, 4
  s_lshr_b32 s35, s35, s45
  s_bfe_u32 s47, s35, 0x3000c
  s_bfe_u32 s44, s35, 0x1000f
  s_lshr_b32 s51, s32, 1
  s_and_b32 s51, s51, s44
  s_and_b32 s35, s35, 0xfff
  s_xor_b32 s47, s47, s33
  s_lshl3_add_u32 s55, s35, s47
  s_mul_i32 s55, s55, 768
  s_mul_i32 s51, s51, 97920
  s_sub_u32 s51, s55, s51
  s_and_b32 s45, s32, 1
  s_lshl_b32 s45, s45, 2
  s_lshl_b32 s46, s32, 3
  v_mul_u32_u24 v1, 2731, v14
  v_lshrrev_b32 v1, 16, v1
  v_mul_u32_u24 v4, 24, v1
  v_sub_u32 v4, v14, v4
  v_lshrrev_b32 v7, 1, v1
  v_xor_b32 v7, s45, v7
  v_xor_b32 v7, v4, v7
  v_add_u32 v1, s46, v1
  v_mul_u32_u24 v10, 6144, v1
  v_lshl_add_u32 v20, v7, 4, v10
  s_mul_i32 s50, s32, 3072
  s_mov_b32 s26, 14739456
  s_mov_b32 s27, 0x20000
  s_mov_b32 m0, s50
  s_waitcnt lgkmcnt(0)
  s_mov_b32 s24, s4
  s_mov_b32 s25, s5
  buffer_load_dwordx4 v20, s[24:27], s51 offen offset:0 nt lds
  v_add_u32 v10, 64, v14
  v_mul_u32_u24 v2, 2731, v10
  v_lshrrev_b32 v2, 16, v2
  v_mul_u32_u24 v5, 24, v2
  v_sub_u32 v5, v10, v5
  v_lshrrev_b32 v8, 1, v2
  v_xor_b32 v8, s45, v8
  v_xor_b32 v8, v5, v8
  v_add_u32 v2, s46, v2
  v_mul_u32_u24 v10, 6144, v2
  v_subrev_u32 v10, 1024, v10
  v_lshl_add_u32 v21, v8, 4, v10
  buffer_load_dwordx4 v21, s[24:27], s51 offen offset:1024 nt lds
  v_add_u32 v10, 128, v14
  v_mul_u32_u24 v3, 2731, v10
  v_lshrrev_b32 v3, 16, v3
  v_mul_u32_u24 v6, 24, v3
  v_sub_u32 v6, v10, v6
  v_lshrrev_b32 v9, 1, v3
  v_xor_b32 v9, s45, v9
  v_xor_b32 v9, v6, v9
  v_add_u32 v3, s46, v3
  v_mul_u32_u24 v10, 6144, v3
  v_subrev_u32 v10, 2048, v10
  v_lshl_add_u32 v22, v9, 4, v10
  buffer_load_dwordx4 v22, s[24:27], s51 offen offset:2048 nt lds
  s_add_u32 m0, s50, 12288
  s_add_u32 s51, s55, 384
  s_cmp_lg_u32 s44, 0
  s_cselect_b32 s51, 0x70000000, s51
  buffer_load_dwordx4 v20, s[24:27], s51 offen offset:0 nt lds
  buffer_load_dwordx4 v21, s[24:27], s51 offen offset:1024 nt lds
  buffer_load_dwordx4 v22, s[24:27], s51 offen offset:2048 nt lds
  s_cmp_lt_u32 s3, 22
  s_cbranch_scc1 L_ASET
  s_mov_b32 m0, s3
  s_mov_b32 s56, 0x198e60
  s_mov_b32 s57, 0x1b0ec0
  s_mov_b32 s58, 0x80e20
  s_mov_b32 s59, 0x90e80
  s_mov_b32 s60, 0xb8ea0
  s_mov_b32 s61, 0x205
  s_mov_b32 s62, 0x245
  s_mov_b32 s63, 0x2e5
  s_mov_b32 s64, 0x80a21
  s_mov_b32 s65, 0x90a81
  s_mov_b32 s66, 0x88aa1
  s_mov_b32 s67, 0xa8ae1
  s_mov_b32 s68, 0x80262
  s_mov_b32 s69, 0x902c2
  s_mov_b32 s70, 0xb82e2
  s_mov_b32 s71, 0x90601
  s_mov_b32 s72, 0x986c1
  s_mov_b32 s73, 0x204
  s_mov_b32 s74, 0x244
  s_mov_b32 s75, 0x264
  s_mov_b32 s76, 0x22c4
  s_mov_b32 s77, 0x2e4
  s_mov_b32 s78, 0x5350030e
  s_mov_b32 s79, 0x74c0234e
  s_mov_b32 s80, 0xe0023ee
  s_mov_b32 s81, 0x3680030f
  s_mov_b32 s82, 0x8750030c
  s_mov_b32 s83, 0x5150034c
  s_mov_b32 s84, 0x72c003ec
  s_mov_b32 s85, 0xc00030d
  s_mov_b32 s86, 0x3480034d
  s_mov_b32 s87, 0x855003ed
  s_mov_b32 s88, 0x1fa0000
  s_mov_b32 s89, 0x8e81fa
  s_mov_b32 s90, 0x1cd0288
  s_mov_b32 s91, 0x1330455
  s_mov_b32 s92, 0x4e8588
  s_mov_b32 s93, 0x9685d6
  s_mov_b32 s94, 0x129066c
  s_mov_b32 s95, 0x1ca0795
  s_movrels_b32 s34, s56
  v_cmp_gt_u32 vcc, 48, v14
  v_mov_b32 v35, 0x70000000
  s_bfe_u32 s52, s34, 0x3000a
  s_xor_b32 s52, s52, s33
  s_lshr_b32 s49, s34, 20
  s_add_u32 s49, s49, s46
  s_lshl3_add_u32 s49, s49, s52
  s_mul_i32 s49, s49, 768
  v_mul_u32_u24 v34, 43, v14
  v_lshrrev_b32 v34, 8, v34
  v_mul_u32_u24 v34, 5376, v34
  v_lshl_add_u32 v34, v14, 7, v34
  v_cndmask_b32 v38, v35, v34, vcc
  s_mov_b32 s68, s49
  s_bfe_u32 m0, s34, 0x30005
  s_mov_b32 s16, s6
  s_movrels_b32 s35, s88
  s_mov_b32 s17, s7
  s_mov_b32 s19, 0x20000
  s_lshr_b32 s36, s35, 16
  s_and_b32 s35, s35, 0xfff
  s_add_u32 s49, s35, s36
  s_mul_i32 s30, s49, 6144
  s_mul_i32 s18, s49, 3072
  s_lshl3_add_u32 s63, s35, s47
  s_mul_i32 s63, s63, 384
  s_sub_u32 s64, s63, 98304
  v_mul_u32_u24 v10, 3072, v1
  v_lshl_add_u32 v23, v7, 4, v10
  v_bfe_u32 v7, v1, 1, 1
  v_lshlrev_b32 v7, 2, v7
  v_xor_b32 v7, v4, v7
  v_lshl_add_u32 v26, v7, 4, v10
  v_mul_u32_u24 v10, 3072, v2
  v_subrev_u32 v10, 1024, v10
  v_lshl_add_u32 v24, v8, 4, v10
  v_bfe_u32 v8, v2, 1, 1
  v_lshlrev_b32 v8, 2, v8
  v_xor_b32 v8, v5, v8
  v_lshl_add_u32 v27, v8, 4, v10
  v_mul_u32_u24 v10, 3072, v3
  v_subrev_u32 v10, 2048, v10
  v_lshl_add_u32 v25, v9, 4, v10
  v_bfe_u32 v9, v3, 1, 1
  v_lshlrev_b32 v9, 2, v9
  v_xor_b32 v9, v6, v9
  v_lshl_add_u32 v28, v9, 4, v10
  s_mov_b32 s20, s8
  s_mov_b32 s21, s9
  s_mov_b32 s22, s18
  s_mov_b32 s23, 0x20000
  s_add_u32 m0, s50, 24576
  s_mov_b32 s23, 0x20000
  buffer_load_dwordx4 v23, s[16:19], s63 offen offset:0  lds
  buffer_load_dwordx4 v24, s[16:19], s63 offen offset:1024  lds
  buffer_load_dwordx4 v25, s[16:19], s63 offen offset:2048  lds
  s_cmp_lt_u32 s3, 25
  s_cbranch_scc1 L_SH9
  s_cmp_lt_u32 s3, 26
  s_cbranch_scc1 L_SH10
  s_cmp_lt_u32 s3, 29
  s_cbranch_scc1 L_SH11
  s_branch L_SH12
L_ASET:
  s_mov_b32 m0, s3
  s_mov_b32 s56, 0x198e60
  s_mov_b32 s57, 0x1b0ec0
  s_mov_b32 s58, 0x80e20
  s_mov_b32 s59, 0x90e80
  s_mov_b32 s60, 0xb8ea0
  s_mov_b32 s61, 0x205
  s_mov_b32 s62, 0x245
  s_mov_b32 s63, 0x2e5
  s_mov_b32 s64, 0x80a21
  s_mov_b32 s65, 0x90a81
  s_mov_b32 s66, 0x88aa1
  s_mov_b32 s67, 0xa8ae1
  s_mov_b32 s68, 0x80262
  s_mov_b32 s69, 0x902c2
  s_mov_b32 s70, 0xb82e2
  s_mov_b32 s71, 0x90601
  s_mov_b32 s72, 0x986c1
  s_mov_b32 s73, 0x204
  s_mov_b32 s74, 0x244
  s_mov_b32 s75, 0x264
  s_mov_b32 s76, 0x22c4
  s_mov_b32 s77, 0x2e4
  s_mov_b32 s78, 0x5350030e
  s_mov_b32 s79, 0x74c0234e
  s_mov_b32 s80, 0xe0023ee
  s_mov_b32 s81, 0x3680030f
  s_mov_b32 s82, 0x8750030c
  s_mov_b32 s83, 0x5150034c
  s_mov_b32 s84, 0x72c003ec
  s_mov_b32 s85, 0xc00030d
  s_mov_b32 s86, 0x3480034d
  s_mov_b32 s87, 0x855003ed
  s_mov_b32 s88, 0x1fa0000
  s_mov_b32 s89, 0x8e81fa
  s_mov_b32 s90, 0x1cd0288
  s_mov_b32 s91, 0x1330455
  s_mov_b32 s92, 0x4e8588
  s_mov_b32 s93, 0x9685d6
  s_mov_b32 s94, 0x129066c
  s_mov_b32 s95, 0x1ca0795
  s_movrels_b32 s34, s56
  s_bfe_u32 m0, s34, 0x30005
  s_mov_b32 s16, s6
  s_movrels_b32 s35, s88
  s_mov_b32 s17, s7
  s_mov_b32 s19, 0x20000
  s_lshr_b32 s36, s35, 16
  s_and_b32 s35, s35, 0xfff
  s_add_u32 s49, s35, s36
  s_mul_i32 s30, s49, 6144
  s_mul_i32 s18, s49, 3072
  s_lshl3_add_u32 s63, s35, s47
  s_mul_i32 s63, s63, 384
  s_sub_u32 s64, s63, 98304
  v_mul_u32_u24 v10, 3072, v1
  v_lshl_add_u32 v23, v7, 4, v10
  v_bfe_u32 v7, v1, 1, 1
  v_lshlrev_b32 v7, 2, v7
  v_xor_b32 v7, v4, v7
  v_lshl_add_u32 v26, v7, 4, v10
  v_mul_u32_u24 v10, 3072, v2
  v_subrev_u32 v10, 1024, v10
  v_lshl_add_u32 v24, v8, 4, v10
  v_bfe_u32 v8, v2, 1, 1
  v_lshlrev_b32 v8, 2, v8
  v_xor_b32 v8, v5, v8
  v_lshl_add_u32 v27, v8, 4, v10
  v_mul_u32_u24 v10, 3072, v3
  v_subrev_u32 v10, 2048, v10
  v_lshl_add_u32 v25, v9, 4, v10
  v_bfe_u32 v9, v3, 1, 1
  v_lshlrev_b32 v9, 2, v9
  v_xor_b32 v9, v6, v9
  v_lshl_add_u32 v28, v9, 4, v10
  s_mov_b32 s20, s8
  s_mov_b32 s21, s9
  s_mov_b32 s22, s18
  s_add_u32 m0, s50, 49152
  s_mov_b32 s23, 0x20000
  buffer_load_dwordx4 v23, s[16:19], s63 offen offset:0  lds
  buffer_load_dwordx4 v24, s[16:19], s63 offen offset:1024  lds
  buffer_load_dwordx4 v25, s[16:19], s63 offen offset:2048  lds
  s_mov_b32 s28, s12
  s_mov_b32 s29, s13
  s_mov_b32 s31, 0x20000
  s_mul_i32 s52, s32, 49152
  s_add_u32 s62, s55, s52
  s_lshl_b32 s52, s32, 6
  s_and_b32 s52, s52, 64
  v_lshrrev_b32 v1, 3, v14
  v_and_b32 v2, 7, v14
  v_mul_u32_u24 v29, 384, v1
  v_lshl_add_u32 v29, v2, 4, v29
  v_add_u32 v29, s50, v29
  v_lshrrev_b32 v3, 4, v14
  v_xor_b32 v2, v2, v3
  v_mul_u32_u24 v30, 6144, v1
  v_lshl_add_u32 v30, v2, 4, v30
  v_xor_b32 v30, s52, v30
  s_bfe_u32 m0, s34, 0x3000f
  s_bfe_u32 s37, s34, 0x5000a
  s_movrels_b32 s35, s88
  s_bfe_u32 s47, s35, 0x3000c
  s_xor_b32 s47, s47, s33
  s_bfe_u32 s68, s35, 0x1000f
  s_lshl_b32 s37, s37, 1
  s_sub_u32 s37, s37, s68
  s_lshr_b32 s36, s35, 16
  s_and_b32 s35, s35, 0xfff
  s_add_u32 s49, s35, s36
  s_mul_i32 s69, s49, 6144
  s_mul_i32 s71, s49, 3072
  s_lshl3_add_u32 s70, s35, s47
  s_lshl_b32 s68, s37, 8
  s_add_u32 s68, s68, s70
  s_mul_i32 s68, s68, 768
  s_mul_i32 s70, s70, 384
  s_cmp_lt_u32 s3, 2
  s_cbranch_scc1 L_SH0
  s_cmp_lt_u32 s3, 5
  s_cbranch_scc1 L_SH1
  s_cmp_lt_u32 s3, 8
  s_cbranch_scc1 L_SH2
  s_cmp_lt_u32 s3, 10
  s_cbranch_scc1 L_SH3
  s_cmp_lt_u32 s3, 11
  s_cbranch_scc1 L_SH4
  s_cmp_lt_u32 s3, 12
  s_cbranch_scc1 L_SH5
  s_cmp_lt_u32 s3, 15
  s_cbranch_scc1 L_SH6
  s_cmp_lt_u32 s3, 17
  s_cbranch_scc1 L_SH7
  s_branch L_SH8
RETH_RX:
  s_mov_b64 exec, -1
L_COMPUTE:
  s_mov_b32 m0, s3
  s_mov_b32 s56, 0x198e60
  s_mov_b32 s57, 0x1b0ec0
  s_mov_b32 s58, 0x80e20
  s_mov_b32 s59, 0x90e80
  s_mov_b32 s60, 0xb8ea0
  s_mov_b32 s61, 0x205
  s_mov_b32 s62, 0x245
  s_mov_b32 s63, 0x2e5
  s_mov_b32 s64, 0x80a21
  s_mov_b32 s65, 0x90a81
  s_mov_b32 s66, 0x88aa1
  s_mov_b32 s67, 0xa8ae1
  s_mov_b32 s68, 0x80262
  s_mov_b32 s69, 0x902c2
  s_mov_b32 s70, 0xb82e2
  s_mov_b32 s71, 0x90601
  s_mov_b32 s72, 0x986c1
  s_mov_b32 s73, 0x204
  s_mov_b32 s74, 0x244
  s_mov_b32 s75, 0x264
  s_mov_b32 s76, 0x22c4
  s_mov_b32 s77, 0x2e4
  s_mov_b32 s78, 0x5350030e
  s_mov_b32 s79, 0x74c0234e
  s_mov_b32 s80, 0xe0023ee
  s_mov_b32 s81, 0x3680030f
  s_mov_b32 s82, 0x8750030c
  s_mov_b32 s83, 0x5150034c
  s_mov_b32 s84, 0x72c003ec
  s_mov_b32 s85, 0xc00030d
  s_mov_b32 s86, 0x3480034d
  s_mov_b32 s87, 0x855003ed
  s_mov_b32 s88, 0x1fa0000
  s_mov_b32 s89, 0x8e81fa
  s_mov_b32 s90, 0x1cd0288
  s_mov_b32 s91, 0x1330455
  s_mov_b32 s92, 0x4e8588
  s_mov_b32 s93, 0x9685d6
  s_mov_b32 s94, 0x129066c
  s_mov_b32 s95, 0x1ca0795
  s_movrels_b32 s34, s56
  s_lshr_b32 s52, s32, 1
  s_and_b32 s53, s32, 1
  s_mul_i32 s27, s52, 12288
  s_mul_i32 s42, s53, 12288
  s_waitcnt lgkmcnt(0)
  s_mov_b32 s28, s12
  s_mov_b32 s29, s13
  s_mov_b32 s31, 0x20000
  s_bfe_u32 m0, s34, 0x30005
  s_and_b32 s37, s34, 31
  s_movrels_b32 s35, s88
  s_bfe_u32 s54, s35, 0x3000c
  s_xor_b32 s54, s54, s33
  s_lshl1_add_u32 s54, s54, s53
  s_mul_i32 s54, s54, 384
  s_bfe_u32 s21, s35, 0x1000f
  s_lshr_b32 s36, s35, 16
  s_and_b32 s35, s35, 0xfff
  s_add_u32 s17, s35, s36
  s_mul_i32 s17, s17, 6144
  s_lshl_b32 s20, s37, 1
  s_sub_u32 s20, s20, s21
  s_add_u32 s21, s20, s52
  s_add_u32 s20, s20, 2
  s_add_u32 s22, s36, 31
  s_lshr_b32 s22, s22, 5
  s_min_u32 s20, s20, s22
  s_add_u32 s19, s21, 1
  s_lshl_b32 s22, s21, 5
  s_cmp_lt_u32 s22, s36
  s_cselect_b32 s19, s19, 0
  s_add_u32 s22, s37, 2
  s_sub_u32 s23, s22, s52
  s_lshr_b32 s22, s22, 1
  s_lshr_b32 s23, s23, 1
  s_bitcmp1_b32 s34, 8
  s_cselect_b32 s18, 2, 1
  s_cselect_b32 s24, s22, s20
  s_cselect_b32 s19, s23, s19
  s_cselect_b32 s21, s37, s21
  s_cselect_b32 s49, s27, 0
  s_lshl_b32 s21, s21, 5
  s_add_u32 s21, s21, s35
  s_mul_i32 s16, s21, 6144
  s_add_u32 s16, s16, s54
  s_lshr_b32 s25, s18, 1
  s_sub_u32 s23, 2, s25
  s_add_u32 s22, s23, 1
  s_and_b32 s20, s22, s25
  s_add_u32 s22, s22, s20
  s_mov_b32 s26, s24
  s_mul_i32 s24, s24, s18
  s_add_u32 s24, s24, s22
  s_mul_i32 s20, s23, 43
  s_lshr_b32 s20, s20, 8
  s_mul_i32 s20, s20, 6
  s_sub_u32 s20, s23, s20
  s_mul_i32 s20, s20, 24576
  s_add_u32 s20, s20, s49
  s_mul_i32 s21, s22, 43
  s_lshr_b32 s21, s21, 8
  s_mul_i32 s21, s21, 6
  s_sub_u32 s21, s22, s21
  s_mul_i32 s21, s21, 24576
  s_add_u32 s21, s21, s49
  s_or_b32 s49, s25, s52
  s_bfe_u32 s55, s34, 0x1000d
  s_bfe_u32 s48, s34, 0x10013
  s_andn2_b32 s55, s55, s48
  s_and_b32 s55, s55, s49
  s_and_b32 s49, s55, s53
  s_cselect_b32 s19, 0, s19
  s_xor_b32 s49, s37, s52
  s_and_b32 s25, s25, s49
  s_bfe_u32 s34, s34, 0xb000a
  v_and_b32 v80, 31, v14
  v_lshrrev_b32 v81, 5, v14
  v_bfe_u32 v82, v14, 1, 3
  v_mul_u32_u24 v83, 384, v80
  v_xor_b32 v84, v81, v82
  v_lshl_add_u32 v15, v84, 4, v83
  v_xor_b32 v16, 32, v15
  v_xor_b32 v17, 64, v15
  v_xor_b32 v18, 96, v15
  v_lshl_add_u32 v21, v82, 4, v83
  v_lshl_add_u32 v21, v81, 3, v21
  v_lshlrev_b32 v22, 4, v14
  v_bfe_u32 v86, v14, 2, 2
  v_lshl_add_u32 v87, v81, 2, v86
  v_mul_u32_u24 v87, 384, v87
  v_bfe_u32 v88, v14, 4, 1
  v_lshl_add_u32 v87, v88, 5, v87
  v_and_b32 v88, 3, v14
  v_lshl_add_u32 v87, v88, 3, v87
  v_bfe_u32 v88, v14, 3, 1
  v_lshlrev_b32 v88, 6, v88
  v_add_u32 v19, v87, v88
  v_sub_u32 v20, v87, v88
  v_lshrrev_b32 v89, 3, v14
  v_and_b32 v90, 7, v14
  v_mul_u32_u24 v23, 384, v89
  v_lshl_add_u32 v23, v90, 4, v23
  v_lshrrev_b32 v91, 4, v14
  v_xor_b32 v90, v90, v91
  v_mul_u32_u24 v24, 6144, v89
  v_lshl_add_u32 v24, v90, 4, v24
  v_xor_b32 v25, 64, v24
  s_mov_b32 s41, 0x3dd53b95
  v_mov_b32 v13, 0xff800000
  s_cmp_lg_u32 s55, 0
  s_cselect_b32 s48, 15, 31
  s_cselect_b32 s55, 0, 8
  s_lshl_b32 s55, 384, s55
  v_and_b32 v80, s48, v80
  s_lshl_b32 s48, s25, 6
  v_lshlrev_b32 v92, 2, v81
  v_sub_u32 v92, v80, v92
  v_add_u32 v92, s48, v92
  v_cmp_gt_i32 s[56:57], 0, v92
  v_cmp_gt_i32 s[58:59], 1, v92
  v_cmp_gt_i32 s[60:61], 2, v92
  v_cmp_gt_i32 s[62:63], 3, v92
  v_cmp_gt_i32 s[64:65], 8, v92
  v_cmp_gt_i32 s[66:67], 9, v92
  v_cmp_gt_i32 s[68:69], 10, v92
  v_cmp_gt_i32 s[70:71], 11, v92
  v_cmp_gt_i32 s[72:73], 16, v92
  v_cmp_gt_i32 s[74:75], 17, v92
  v_cmp_gt_i32 s[76:77], 18, v92
  v_cmp_gt_i32 s[78:79], 19, v92
  v_cmp_gt_i32 s[80:81], 24, v92
  v_cmp_gt_i32 s[82:83], 25, v92
  v_cmp_gt_i32 s[84:85], 26, v92
  v_cmp_gt_i32 s[86:87], 27, v92
  s_cmp_lg_u32 s19, s26
  s_cselect_b32 s48, 1, s52
  s_lshl_b32 s48, s48, 1
  s_xor_b32 s48, s48, s32
  s_cmp_eq_u32 s18, 2
  s_cselect_b32 s50, s53, s48
  s_mul_i32 s50, s50, 12288
  v_add_u32 v96, s50, v15
  v_add_u32 v97, s50, v16
  v_add_u32 v98, s50, v17
  v_add_u32 v99, s50, v18
  v_add_u32 v1, s20, v15
  v_add_u32 v2, s20, v16
  v_add_u32 v3, s20, v17
  v_add_u32 v4, s20, v18
  s_mov_b32 s44, s16
  s_mov_b32 s30, s17
  s_mov_b32 s40, s19
  s_mov_b32 s46, s21
  s_mov_b32 s45, s24
  s_mov_b32 s39, s26
  s_mov_b32 s38, s18
  s_mul_i32 s47, s38, 24576
  s_mul_i32 s48, s38, 12288
  v_mov_b32 v0, s48
  s_sub_u32 s43, s40, 2
  s_mul_i32 s48, s45, 43
  s_lshr_b32 s48, s48, 8
  s_mul_i32 s48, s48, 6
  s_sub_u32 s51, s45, s48
  s_bfe_u32 s3, s34, 0x10009
  s_add_u32 s50, s51, s52
  s_sub_u32 s48, s50, 6
  s_min_u32 s50, s50, s48
  s_mul_i32 s50, s50, 24576
  s_add_u32 s50, s50, s42
  s_bfe_u32 m0, s34, 0x30005
  s_and_b32 s37, s34, 31
  s_movrels_b32 s35, s88
  s_bfe_u32 s54, s35, 0x3000c
  s_xor_b32 s54, s54, s33
  s_lshl1_add_u32 s54, s54, s53
  s_mul_i32 s54, s54, 384
  s_bfe_u32 s21, s35, 0x1000f
  s_lshr_b32 s36, s35, 16
  s_and_b32 s35, s35, 0xfff
  s_add_u32 s17, s35, s36
  s_mul_i32 s17, s17, 6144
  s_lshl_b32 s20, s37, 1
  s_sub_u32 s20, s20, s21
  s_add_u32 s21, s20, s52
  s_add_u32 s20, s20, 2
  s_add_u32 s22, s36, 31
  s_lshr_b32 s22, s22, 5
  s_min_u32 s26, s20, s22
  s_add_u32 s19, s21, 1
  s_lshl_b32 s21, s21, 5
  s_cmp_lt_u32 s21, s36
  s_cselect_b32 s19, s19, 0
  s_add_u32 s21, s21, s35
  s_mul_i32 s16, s21, 6144
  s_add_u32 s16, s16, s54
  s_add_u32 s24, s45, 2
  s_add_u32 s20, s51, 5
  s_sub_u32 s48, s20, 6
  s_min_u32 s20, s20, s48
  s_add_u32 s21, s51, 2
  s_sub_u32 s48, s21, 6
  s_min_u32 s21, s21, s48
  s_bitcmp1_b32 s34, 10
  s_cselect_b32 s20, 2, s20
  s_cselect_b32 s21, 3, s21
  s_cselect_b32 s24, 3, s24
  s_add_u32 s24, s24, s26
  s_mul_i32 s20, s20, 24576
  s_mul_i32 s21, s21, 24576
  s_cmp_eq_u32 s40, 0
  s_cbranch_scc1 L_IDLE
  s_cmp_eq_u32 s38, 2
  s_cbranch_scc1 L_G0
  s_cmp_eq_u32 s40, s39
  s_cbranch_scc1 L_G0
  s_mov_b32 s39, s40
  s_barrier
  s_branch L_G0
L_IDLE:
  s_add_u32 s43, s39, 1
  s_mul_i32 s48, s45, 43
  s_lshr_b32 s48, s48, 8
  s_mul_i32 s48, s48, 6
  s_sub_u32 s51, s45, s48
  s_bfe_u32 s3, s34, 0x10009
  s_add_u32 s50, s51, s52
  s_sub_u32 s48, s50, 6
  s_min_u32 s50, s50, s48
  s_mul_i32 s50, s50, 24576
  s_add_u32 s50, s50, s42
  v_add_u32 v96, s50, v21
  v_add_u32 v104, s50, v23
  v_xor_b32 v97, 16, v96
  v_xor_b32 v98, 32, v96
  v_xor_b32 v99, 48, v96
  v_xor_b32 v100, 64, v96
  v_xor_b32 v101, 80, v96
  v_xor_b32 v102, 96, v96
  v_xor_b32 v103, 112, v96
L_IDLE1:
  s_barrier
  s_sub_u32 s43, s43, 1
  s_cmp_lg_u32 s43, 0
  s_cbranch_scc1 L_IDLE1
  s_cmp_eq_u32 s3, 0
  s_cbranch_scc1 L_END
  s_branch L_NOXB
.p2align 12
L_G0:
  s_cbranch_execz RETH_R2
  s_barrier
  ds_read_b128 v[64:67], v1 offset:0
  ds_read_b128 v[112:115], v96 offset:0
  ds_read_b128 v[68:71], v2 offset:0
  ds_read_b128 v[116:119], v97 offset:0
  ds_read_b128 v[72:75], v3 offset:0
  ds_read_b128 v[120:123], v98 offset:0
  ds_read_b128 v[76:79], v4 offset:0
  ds_read_b128 v[124:127], v99 offset:0
  ds_read_b128 v[48:51], v1 offset:128
  ds_read_b128 v[128:131], v96 offset:128
  ds_read_b128 v[52:55], v2 offset:128
  ds_read_b128 v[132:135], v97 offset:128
  ds_read_b128 v[136:139], v98 offset:128
  ds_read_b128 v[140:143], v99 offset:128
  ds_read_b128 v[144:147], v96 offset:256
  ds_read_b128 v[148:151], v97 offset:256
  ds_read_b128 v[152:155], v98 offset:256
  ds_read_b128 v[156:159], v99 offset:256
  s_waitcnt lgkmcnt(15)
  v_mfma_f32_32x32x16_bf16 v[80:95], v[64:67], v[112:115], 0
  ds_read_b128 v[56:59], v3 offset:128
  s_waitcnt lgkmcnt(15)
  v_mfma_f32_32x32x16_bf16 v[80:95], v[68:71], v[116:119], v[80:95]
  ds_read_b128 v[60:63], v4 offset:128
  s_waitcnt lgkmcnt(14)
  v_mfma_f32_32x32x16_bf16 v[80:95], v[72:75], v[120:123], v[80:95]
  ds_read_b128 v[64:67], v1 offset:256
  s_waitcnt lgkmcnt(13)
  v_mfma_f32_32x32x16_bf16 v[80:95], v[76:79], v[124:127], v[80:95]
  ds_read_b128 v[68:71], v2 offset:256
  s_waitcnt lgkmcnt(12)
  v_mfma_f32_32x32x16_bf16 v[80:95], v[48:51], v[128:131], v[80:95]
  ds_read_b128 v[72:75], v3 offset:256
  s_waitcnt lgkmcnt(11)
  v_mfma_f32_32x32x16_bf16 v[80:95], v[52:55], v[132:135], v[80:95]
  ds_read_b128 v[76:79], v4 offset:256
  s_waitcnt lgkmcnt(5)
  v_mfma_f32_32x32x16_bf16 v[80:95], v[56:59], v[136:139], v[80:95]
  v_add_u32 v1, s46, v15
  v_add_u32 v2, s46, v16
  v_add_u32 v3, s46, v17
  v_add_u32 v4, s46, v18
  s_barrier
  ds_read_b128 v[48:51], v1 offset:0
  s_waitcnt lgkmcnt(5)
  v_mfma_f32_32x32x16_bf16 v[80:95], v[60:63], v[140:143], v[80:95]
  ds_read_b128 v[52:55], v2 offset:0
  v_add3_u32 v5, s46, v19, v0
  v_add3_u32 v6, s46, v20, v0
  s_waitcnt lgkmcnt(5)
  v_mfma_f32_32x32x16_bf16 v[80:95], v[64:67], v[144:147], v[80:95]
  ds_read_b128 v[56:59], v3 offset:0
  s_waitcnt lgkmcnt(5)
  v_mfma_f32_32x32x16_bf16 v[80:95], v[68:71], v[148:151], v[80:95]
  ds_read_b128 v[60:63], v4 offset:0
  s_waitcnt lgkmcnt(5)
  v_mfma_f32_32x32x16_bf16 v[80:95], v[72:75], v[152:155], v[80:95]
  ds_read_b128 v[64:67], v1 offset:128
  s_waitcnt lgkmcnt(5)
  v_mfma_f32_32x32x16_bf16 v[80:95], v[76:79], v[156:159], v[80:95]
  ds_read_b128 v[68:71], v2 offset:128
  v_mov_b32 v8, 0
  v_mov_b32 v7, 0
  s_cmp_eq_u32 s40, 1
  s_cbranch_scc1 L_ONE
L_AF:
  s_waitcnt lgkmcnt(3)
  v_mfma_f32_32x32x16_bf16 v[96:111], v[48:51], v[112:115], 0
  ds_read_b128 v[72:75], v3 offset:128
  s_sub_u32 s43, s43, 1
  s_nop 1
  v_mfma_f32_32x32x16_bf16 v[96:111], v[52:55], v[116:119], v[96:111]
  ds_read_b128 v[76:79], v4 offset:128
  v_fma_f32 v80, v80, s41, -v7
  v_fma_f32 v81, v81, s41, -v7
  v_fma_f32 v82, v82, s41, -v7
  v_fma_f32 v83, v83, s41, -v7
  v_exp_f32 v32, v80
  v_fma_f32 v84, v84, s41, -v7
  v_mfma_f32_32x32x16_bf16 v[96:111], v[56:59], v[120:123], v[96:111]
  ds_read_b128 v[48:51], v1 offset:256
  v_exp_f32 v33, v81
  v_fma_f32 v85, v85, s41, -v7
  v_exp_f32 v34, v82
  v_fma_f32 v86, v86, s41, -v7
  s_waitcnt lgkmcnt(3)
  v_mfma_f32_32x32x16_bf16 v[96:111], v[60:63], v[124:127], v[96:111]
  ds_read_b128 v[52:55], v2 offset:256
  v_exp_f32 v35, v83
  v_fma_f32 v87, v87, s41, -v7
  v_exp_f32 v36, v84
  v_fma_f32 v88, v88, s41, -v7
  v_add_f32 v9, v32, v33
  v_cvt_pk_bf16_f32 v40, v32, v33
  v_mfma_f32_32x32x16_bf16 v[96:111], v[64:67], v[128:131], v[96:111]
  ds_read_b128 v[56:59], v3 offset:256
  v_exp_f32 v37, v85
  v_fma_f32 v89, v89, s41, -v7
  v_add_f32 v9, v9, v34
  v_exp_f32 v38, v86
  v_fma_f32 v90, v90, s41, -v7
  v_add_f32 v9, v9, v35
  v_mfma_f32_32x32x16_bf16 v[96:111], v[68:71], v[132:135], v[96:111]
  ds_read_b128 v[60:63], v4 offset:256
  v_cvt_pk_bf16_f32 v41, v34, v35
  v_exp_f32 v39, v87
  v_fma_f32 v91, v91, s41, -v7
  v_add_f32 v9, v9, v36
  v_exp_f32 v32, v88
  s_waitcnt lgkmcnt(3)
  v_mfma_f32_32x32x16_bf16 v[96:111], v[72:75], v[136:139], v[96:111]
  ds_read_b64_tr_b16 v[64:65], v5 offset:0
  ds_read_b64_tr_b16 v[66:67], v5 offset:3072
  v_fma_f32 v92, v92, s41, -v7
  v_add_f32 v9, v9, v37
  v_cvt_pk_bf16_f32 v42, v36, v37
  v_exp_f32 v33, v89
  v_fma_f32 v93, v93, s41, -v7
  v_add_f32 v9, v9, v38
  v_mfma_f32_32x32x16_bf16 v[96:111], v[76:79], v[140:143], v[96:111]
  ds_read_b64_tr_b16 v[68:69], v6 offset:64
  ds_read_b64_tr_b16 v[70:71], v6 offset:3136
  v_exp_f32 v34, v90
  v_fma_f32 v94, v94, s41, -v7
  v_add_f32 v9, v9, v39
  v_cvt_pk_bf16_f32 v43, v38, v39
  v_exp_f32 v35, v91
  v_mfma_f32_32x32x16_bf16 v[96:111], v[48:51], v[144:147], v[96:111]
  ds_read_b64_tr_b16 v[72:73], v5 offset:128
  ds_read_b64_tr_b16 v[74:75], v5 offset:3200
  v_fma_f32 v95, v95, s41, -v7
  v_add_f32 v9, v9, v32
  v_exp_f32 v36, v92
  v_add_f32 v9, v9, v33
  v_cvt_pk_bf16_f32 v44, v32, v33
  s_waitcnt lgkmcnt(6)
  v_mfma_f32_32x32x16_bf16 v[96:111], v[52:55], v[148:151], v[96:111]
  ds_read_b64_tr_b16 v[76:77], v6 offset:192
  ds_read_b64_tr_b16 v[78:79], v6 offset:3264
  v_exp_f32 v37, v93
  v_add_f32 v9, v9, v34
  v_exp_f32 v38, v94
  v_add_f32 v9, v9, v35
  v_mfma_f32_32x32x16_bf16 v[96:111], v[56:59], v[152:155], v[96:111]
  ds_read_b64_tr_b16 v[48:49], v5 offset:256
  ds_read_b64_tr_b16 v[50:51], v5 offset:3328
  v_cvt_pk_bf16_f32 v45, v34, v35
  v_exp_f32 v39, v95
  v_add_f32 v9, v9, v36
  v_add_f32 v9, v9, v37
  v_cvt_pk_bf16_f32 v46, v36, v37
  v_add_f32 v9, v9, v38
  v_mfma_f32_32x32x16_bf16 v[96:111], v[60:63], v[156:159], v[96:111]
  ds_read_b64_tr_b16 v[52:53], v6 offset:320
  ds_read_b64_tr_b16 v[54:55], v6 offset:3392
  v_add_f32 v9, v9, v39
  v_cvt_pk_bf16_f32 v47, v38, v39
  v_subrev_u32 v11, 0x33800000, v9
  v_cmp_lt_u32 vcc, 0x11000000, v11
  s_cbranch_vccnz RAREF_0
RETF:
  s_cbranch_scc1 TAIL_0z
  s_waitcnt lgkmcnt(6)
  v_mfma_f32_32x32x16_bf16 v[160:175], v[64:67], v[40:43], 0
  ds_read_b64_tr_b16 v[56:57], v5 offset:6144
  ds_read_b64_tr_b16 v[58:59], v5 offset:9216
  v_add_f32 v8, v8, v9
  s_add_u32 s48, s46, s47
  s_sub_u32 s49, s48, 147456
  v_mfma_f32_32x32x16_bf16 v[176:191], v[68:71], v[40:43], 0
  ds_read_b64_tr_b16 v[60:61], v6 offset:6208
  ds_read_b64_tr_b16 v[62:63], v6 offset:9280
  s_min_u32 s46, s48, s49
  v_add_u32 v1, s46, v15
  v_add_u32 v2, s46, v16
  v_mfma_f32_32x32x16_bf16 v[192:207], v[72:75], v[40:43], 0
  ds_read_b64_tr_b16 v[64:65], v5 offset:6272
  ds_read_b64_tr_b16 v[66:67], v5 offset:9344
  v_add_u32 v3, s46, v17
  v_add_u32 v4, s46, v18
  v_fma_f32 v96, v96, s41, -v7
  s_waitcnt lgkmcnt(6)
  v_mfma_f32_32x32x16_bf16 v[208:223], v[76:79], v[40:43], 0
  ds_read_b64_tr_b16 v[68:69], v6 offset:6336
  ds_read_b64_tr_b16 v[70:71], v6 offset:9408
  v_fma_f32 v97, v97, s41, -v7
  v_fma_f32 v98, v98, s41, -v7
  v_fma_f32 v99, v99, s41, -v7
  v_mfma_f32_32x32x16_bf16 v[224:239], v[48:51], v[40:43], 0
  ds_read_b64_tr_b16 v[72:73], v5 offset:6400
  ds_read_b64_tr_b16 v[74:75], v5 offset:9472
  v_exp_f32 v32, v96
  v_fma_f32 v100, v100, s41, -v7
  v_mfma_f32_32x32x16_bf16 v[240:255], v[52:55], v[40:43], 0
  ds_read_b64_tr_b16 v[76:77], v6 offset:6464
  ds_read_b64_tr_b16 v[78:79], v6 offset:9536
  v_exp_f32 v33, v97
  v_fma_f32 v101, v101, s41, -v7
  s_waitcnt lgkmcnt(6)
  v_mfma_f32_32x32x16_bf16 v[160:175], v[56:59], v[44:47], v[160:175]
  s_barrier
  ds_read_b128 v[48:51], v1 offset:0
  v_exp_f32 v34, v98
  v_mfma_f32_32x32x16_bf16 v[176:191], v[60:63], v[44:47], v[176:191]
  ds_read_b128 v[52:55], v2 offset:0
  v_fma_f32 v102, v102, s41, -v7
  v_exp_f32 v35, v99
  v_fma_f32 v103, v103, s41, -v7
  v_mfma_f32_32x32x16_bf16 v[192:207], v[64:67], v[44:47], v[192:207]
  ds_read_b128 v[56:59], v3 offset:0
  v_exp_f32 v36, v100
  v_fma_f32 v104, v104, s41, -v7
  v_add_f32 v9, v32, v33
  s_waitcnt lgkmcnt(3)
  v_mfma_f32_32x32x16_bf16 v[208:223], v[68:71], v[44:47], v[208:223]
  ds_read_b128 v[60:63], v4 offset:0
  v_cvt_pk_bf16_f32 v40, v32, v33
  v_exp_f32 v37, v101
  v_fma_f32 v105, v105, s41, -v7
  v_add_f32 v9, v9, v34
  v_mfma_f32_32x32x16_bf16 v[224:239], v[72:75], v[44:47], v[224:239]
  ds_read_b128 v[64:67], v1 offset:128
  v_add3_u32 v5, s46, v19, v0
  v_exp_f32 v38, v102
  v_fma_f32 v106, v106, s41, -v7
  v_add_f32 v9, v9, v35
  v_mfma_f32_32x32x16_bf16 v[240:255], v[76:79], v[44:47], v[240:255]
  ds_read_b128 v[68:71], v2 offset:128
  v_add3_u32 v6, s46, v20, v0
L_LOOP:
  s_waitcnt lgkmcnt(3)
  v_mfma_f32_32x32x16_bf16 v[80:95], v[48:51], v[112:115], 0
  ds_read_b128 v[72:75], v3 offset:128
  s_sub_u32 s43, s43, 1
  v_cvt_pk_bf16_f32 v41, v34, v35
  v_exp_f32 v39, v103
  v_mfma_f32_32x32x16_bf16 v[80:95], v[52:55], v[116:119], v[80:95]
  ds_read_b128 v[76:79], v4 offset:128
  v_fma_f32 v107, v107, s41, -v7
  v_add_f32 v9, v9, v36
  v_exp_f32 v32, v104
  v_fma_f32 v108, v108, s41, -v7
  v_mfma_f32_32x32x16_bf16 v[80:95], v[56:59], v[120:123], v[80:95]
  ds_read_b128 v[48:51], v1 offset:256
  v_add_f32 v9, v9, v37
  v_cvt_pk_bf16_f32 v42, v36, v37
  v_exp_f32 v33, v105
  s_waitcnt lgkmcnt(3)
  v_mfma_f32_32x32x16_bf16 v[80:95], v[60:63], v[124:127], v[80:95]
  ds_read_b128 v[52:55], v2 offset:256
  v_fma_f32 v109, v109, s41, -v7
  v_add_f32 v9, v9, v38
  v_exp_f32 v34, v106
  v_fma_f32 v110, v110, s41, -v7
  v_mfma_f32_32x32x16_bf16 v[80:95], v[64:67], v[128:131], v[80:95]
  ds_read_b128 v[56:59], v3 offset:256
  v_add_f32 v9, v9, v39
  v_cvt_pk_bf16_f32 v43, v38, v39
  v_exp_f32 v35, v107
  v_mfma_f32_32x32x16_bf16 v[80:95], v[68:71], v[132:135], v[80:95]
  ds_read_b128 v[60:63], v4 offset:256
  v_fma_f32 v111, v111, s41, -v7
  v_add_f32 v9, v9, v32
  v_exp_f32 v36, v108
  s_waitcnt lgkmcnt(3)
  v_mfma_f32_32x32x16_bf16 v[80:95], v[72:75], v[136:139], v[80:95]
  ds_read_b64_tr_b16 v[64:65], v5 offset:0
  ds_read_b64_tr_b16 v[66:67], v5 offset:3072
  v_add_f32 v9, v9, v33
  v_cvt_pk_bf16_f32 v44, v32, v33
  v_exp_f32 v37, v109
  v_mfma_f32_32x32x16_bf16 v[80:95], v[76:79], v[140:143], v[80:95]
  ds_read_b64_tr_b16 v[68:69], v6 offset:64
  ds_read_b64_tr_b16 v[70:71], v6 offset:3136
  v_add_f32 v9, v9, v34
  v_exp_f32 v38, v110
  v_add_f32 v9, v9, v35
  v_mfma_f32_32x32x16_bf16 v[80:95], v[48:51], v[144:147], v[80:95]
  ds_read_b64_tr_b16 v[72:73], v5 offset:128
  ds_read_b64_tr_b16 v[74:75], v5 offset:3200
  v_cvt_pk_bf16_f32 v45, v34, v35
  v_exp_f32 v39, v111
  s_waitcnt lgkmcnt(6)
  v_mfma_f32_32x32x16_bf16 v[80:95], v[52:55], v[148:151], v[80:95]
  ds_read_b64_tr_b16 v[76:77], v6 offset:192
  ds_read_b64_tr_b16 v[78:79], v6 offset:3264
  v_add_f32 v9, v9, v36
  v_add_f32 v9, v9, v37
  v_cvt_pk_bf16_f32 v46, v36, v37
  v_mfma_f32_32x32x16_bf16 v[80:95], v[56:59], v[152:155], v[80:95]
  ds_read_b64_tr_b16 v[48:49], v5 offset:256
  ds_read_b64_tr_b16 v[50:51], v5 offset:3328
  v_add_f32 v9, v9, v38
  v_add_f32 v9, v9, v39
  v_cvt_pk_bf16_f32 v47, v38, v39
  v_cmp_lt_f32 vcc, 0x44800000, v9
  v_mfma_f32_32x32x16_bf16 v[80:95], v[60:63], v[156:159], v[80:95]
  ds_read_b64_tr_b16 v[52:53], v6 offset:320
  ds_read_b64_tr_b16 v[54:55], v6 offset:3392
  s_cbranch_vccnz RARES_1
RETR_1:
  s_cbranch_scc1 TAIL_1
  s_waitcnt lgkmcnt(6)
  v_mfma_f32_32x32x16_bf16 v[160:175], v[64:67], v[40:43], v[160:175]
  ds_read_b64_tr_b16 v[56:57], v5 offset:6144
  ds_read_b64_tr_b16 v[58:59], v5 offset:9216
  v_add_f32 v8, v8, v9
  s_add_u32 s48, s46, s47
  s_sub_u32 s49, s48, 147456
  v_mfma_f32_32x32x16_bf16 v[176:191], v[68:71], v[40:43], v[176:191]
  ds_read_b64_tr_b16 v[60:61], v6 offset:6208
  ds_read_b64_tr_b16 v[62:63], v6 offset:9280
  s_min_u32 s46, s48, s49
  v_add_u32 v1, s46, v15
  v_add_u32 v2, s46, v16
  v_mfma_f32_32x32x16_bf16 v[192:207], v[72:75], v[40:43], v[192:207]
  ds_read_b64_tr_b16 v[64:65], v5 offset:6272
  ds_read_b64_tr_b16 v[66:67], v5 offset:9344
  v_add_u32 v3, s46, v17
  v_add_u32 v4, s46, v18
  v_fma_f32 v80, v80, s41, -v7
  s_waitcnt lgkmcnt(6)
  v_mfma_f32_32x32x16_bf16 v[208:223], v[76:79], v[40:43], v[208:223]
  ds_read_b64_tr_b16 v[68:69], v6 offset:6336
  ds_read_b64_tr_b16 v[70:71], v6 offset:9408
  v_fma_f32 v81, v81, s41, -v7
  v_fma_f32 v82, v82, s41, -v7
  v_fma_f32 v83, v83, s41, -v7
  v_mfma_f32_32x32x16_bf16 v[224:239], v[48:51], v[40:43], v[224:239]
  ds_read_b64_tr_b16 v[72:73], v5 offset:6400
  ds_read_b64_tr_b16 v[74:75], v5 offset:9472
  v_exp_f32 v32, v80
  v_fma_f32 v84, v84, s41, -v7
  v_mfma_f32_32x32x16_bf16 v[240:255], v[52:55], v[40:43], v[240:255]
  ds_read_b64_tr_b16 v[76:77], v6 offset:6464
  ds_read_b64_tr_b16 v[78:79], v6 offset:9536
  v_exp_f32 v33, v81
  v_fma_f32 v85, v85, s41, -v7
  s_waitcnt lgkmcnt(6)
  v_mfma_f32_32x32x16_bf16 v[160:175], v[56:59], v[44:47], v[160:175]
  s_barrier
  ds_read_b128 v[48:51], v1 offset:0
  v_exp_f32 v34, v82
  v_mfma_f32_32x32x16_bf16 v[176:191], v[60:63], v[44:47], v[176:191]
  ds_read_b128 v[52:55], v2 offset:0
  v_fma_f32 v86, v86, s41, -v7
  v_exp_f32 v35, v83
  v_fma_f32 v87, v87, s41, -v7
  v_mfma_f32_32x32x16_bf16 v[192:207], v[64:67], v[44:47], v[192:207]
  ds_read_b128 v[56:59], v3 offset:0
  v_exp_f32 v36, v84
  v_fma_f32 v88, v88, s41, -v7
  v_add_f32 v9, v32, v33
  s_waitcnt lgkmcnt(3)
  v_mfma_f32_32x32x16_bf16 v[208:223], v[68:71], v[44:47], v[208:223]
  ds_read_b128 v[60:63], v4 offset:0
  v_cvt_pk_bf16_f32 v40, v32, v33
  v_exp_f32 v37, v85
  v_fma_f32 v89, v89, s41, -v7
  v_add_f32 v9, v9, v34
  v_mfma_f32_32x32x16_bf16 v[224:239], v[72:75], v[44:47], v[224:239]
  ds_read_b128 v[64:67], v1 offset:128
  v_add3_u32 v5, s46, v19, v0
  v_exp_f32 v38, v86
  v_fma_f32 v90, v90, s41, -v7
  v_mfma_f32_32x32x16_bf16 v[240:255], v[76:79], v[44:47], v[240:255]
  ds_read_b128 v[68:71], v2 offset:128
  v_add3_u32 v6, s46, v20, v0
  v_add_f32 v9, v9, v35
  v_cvt_pk_bf16_f32 v41, v34, v35
  s_waitcnt lgkmcnt(3)
  v_mfma_f32_32x32x16_bf16 v[96:111], v[48:51], v[112:115], 0
  ds_read_b128 v[72:75], v3 offset:128
  s_sub_u32 s43, s43, 1
  v_exp_f32 v39, v87
  v_fma_f32 v91, v91, s41, -v7
  v_add_f32 v9, v9, v36
  v_mfma_f32_32x32x16_bf16 v[96:111], v[52:55], v[116:119], v[96:111]
  ds_read_b128 v[76:79], v4 offset:128
  v_exp_f32 v32, v88
  v_fma_f32 v92, v92, s41, -v7
  v_add_f32 v9, v9, v37
  v_cvt_pk_bf16_f32 v42, v36, v37
  v_mfma_f32_32x32x16_bf16 v[96:111], v[56:59], v[120:123], v[96:111]
  ds_read_b128 v[48:51], v1 offset:256
  v_exp_f32 v33, v89
  v_fma_f32 v93, v93, s41, -v7
  s_waitcnt lgkmcnt(3)
  v_mfma_f32_32x32x16_bf16 v[96:111], v[60:63], v[124:127], v[96:111]
  ds_read_b128 v[52:55], v2 offset:256
  v_add_f32 v9, v9, v38
  v_exp_f32 v34, v90
  v_fma_f32 v94, v94, s41, -v7
  v_add_f32 v9, v9, v39
  v_mfma_f32_32x32x16_bf16 v[96:111], v[64:67], v[128:131], v[96:111]
  ds_read_b128 v[56:59], v3 offset:256
  v_cvt_pk_bf16_f32 v43, v38, v39
  v_exp_f32 v35, v91
  v_fma_f32 v95, v95, s41, -v7
  v_mfma_f32_32x32x16_bf16 v[96:111], v[68:71], v[132:135], v[96:111]
  ds_read_b128 v[60:63], v4 offset:256
  v_add_f32 v9, v9, v32
  v_exp_f32 v36, v92
  v_add_f32 v9, v9, v33
  s_waitcnt lgkmcnt(3)
  v_mfma_f32_32x32x16_bf16 v[96:111], v[72:75], v[136:139], v[96:111]
  ds_read_b64_tr_b16 v[64:65], v5 offset:0
  ds_read_b64_tr_b16 v[66:67], v5 offset:3072
  v_cvt_pk_bf16_f32 v44, v32, v33
  v_exp_f32 v37, v93
  v_add_f32 v9, v9, v34
  v_mfma_f32_32x32x16_bf16 v[96:111], v[76:79], v[140:143], v[96:111]
  ds_read_b64_tr_b16 v[68:69], v6 offset:64
  ds_read_b64_tr_b16 v[70:71], v6 offset:3136
  v_exp_f32 v38, v94
  v_add_f32 v9, v9, v35
  v_mfma_f32_32x32x16_bf16 v[96:111], v[48:51], v[144:147], v[96:111]
  ds_read_b64_tr_b16 v[72:73], v5 offset:128
  ds_read_b64_tr_b16 v[74:75], v5 offset:3200
  v_cvt_pk_bf16_f32 v45, v34, v35
  v_exp_f32 v39, v95
  s_waitcnt lgkmcnt(6)
  v_mfma_f32_32x32x16_bf16 v[96:111], v[52:55], v[148:151], v[96:111]
  ds_read_b64_tr_b16 v[76:77], v6 offset:192
  ds_read_b64_tr_b16 v[78:79], v6 offset:3264
  v_add_f32 v9, v9, v36
  v_add_f32 v9, v9, v37
  v_cvt_pk_bf16_f32 v46, v36, v37
  v_mfma_f32_32x32x16_bf16 v[96:111], v[56:59], v[152:155], v[96:111]
  ds_read_b64_tr_b16 v[48:49], v5 offset:256
  ds_read_b64_tr_b16 v[50:51], v5 offset:3328
  v_add_f32 v9, v9, v38
  v_add_f32 v9, v9, v39
  v_cvt_pk_bf16_f32 v47, v38, v39
  v_cmp_lt_f32 vcc, 0x44800000, v9
  v_mfma_f32_32x32x16_bf16 v[96:111], v[60:63], v[156:159], v[96:111]
  ds_read_b64_tr_b16 v[52:53], v6 offset:320
  ds_read_b64_tr_b16 v[54:55], v6 offset:3392
  s_cbranch_vccnz RARES_0
RETR_0:
  s_cbranch_scc1 TAIL_0
  s_waitcnt lgkmcnt(6)
  v_mfma_f32_32x32x16_bf16 v[160:175], v[64:67], v[40:43], v[160:175]
  ds_read_b64_tr_b16 v[56:57], v5 offset:6144
  ds_read_b64_tr_b16 v[58:59], v5 offset:9216
  v_add_f32 v8, v8, v9
  s_add_u32 s48, s46, s47
  s_sub_u32 s49, s48, 147456
  v_mfma_f32_32x32x16_bf16 v[176:191], v[68:71], v[40:43], v[176:191]
  ds_read_b64_tr_b16 v[60:61], v6 offset:6208
  ds_read_b64_tr_b16 v[62:63], v6 offset:9280
  s_min_u32 s46, s48, s49
  v_add_u32 v1, s46, v15
  v_add_u32 v2, s46, v16
  v_mfma_f32_32x32x16_bf16 v[192:207], v[72:75], v[40:43], v[192:207]
  ds_read_b64_tr_b16 v[64:65], v5 offset:6272
  ds_read_b64_tr_b16 v[66:67], v5 offset:9344
  v_add_u32 v3, s46, v17
  v_add_u32 v4, s46, v18
  v_fma_f32 v96, v96, s41, -v7
  s_waitcnt lgkmcnt(6)
  v_mfma_f32_32x32x16_bf16 v[208:223], v[76:79], v[40:43], v[208:223]
  ds_read_b64_tr_b16 v[68:69], v6 offset:6336
  ds_read_b64_tr_b16 v[70:71], v6 offset:9408
  v_fma_f32 v97, v97, s41, -v7
  v_fma_f32 v98, v98, s41, -v7
  v_fma_f32 v99, v99, s41, -v7
  v_mfma_f32_32x32x16_bf16 v[224:239], v[48:51], v[40:43], v[224:239]
  ds_read_b64_tr_b16 v[72:73], v5 offset:6400
  ds_read_b64_tr_b16 v[74:75], v5 offset:9472
  v_exp_f32 v32, v96
  v_fma_f32 v100, v100, s41, -v7
  v_mfma_f32_32x32x16_bf16 v[240:255], v[52:55], v[40:43], v[240:255]
  ds_read_b64_tr_b16 v[76:77], v6 offset:6464
  ds_read_b64_tr_b16 v[78:79], v6 offset:9536
  v_exp_f32 v33, v97
  v_fma_f32 v101, v101, s41, -v7
  s_waitcnt lgkmcnt(6)
  v_mfma_f32_32x32x16_bf16 v[160:175], v[56:59], v[44:47], v[160:175]
  s_barrier
  ds_read_b128 v[48:51], v1 offset:0
  v_exp_f32 v34, v98
  v_mfma_f32_32x32x16_bf16 v[176:191], v[60:63], v[44:47], v[176:191]
  ds_read_b128 v[52:55], v2 offset:0
  v_fma_f32 v102, v102, s41, -v7
  v_exp_f32 v35, v99
  v_fma_f32 v103, v103, s41, -v7
  v_mfma_f32_32x32x16_bf16 v[192:207], v[64:67], v[44:47], v[192:207]
  ds_read_b128 v[56:59], v3 offset:0
  v_exp_f32 v36, v100
  v_fma_f32 v104, v104, s41, -v7
  v_add_f32 v9, v32, v33
  s_waitcnt lgkmcnt(3)
  v_mfma_f32_32x32x16_bf16 v[208:223], v[68:71], v[44:47], v[208:223]
  ds_read_b128 v[60:63], v4 offset:0
  v_cvt_pk_bf16_f32 v40, v32, v33
  v_exp_f32 v37, v101
  v_fma_f32 v105, v105, s41, -v7
  v_add_f32 v9, v9, v34
  v_mfma_f32_32x32x16_bf16 v[224:239], v[72:75], v[44:47], v[224:239]
  ds_read_b128 v[64:67], v1 offset:128
  v_add3_u32 v5, s46, v19, v0
  v_exp_f32 v38, v102
  v_fma_f32 v106, v106, s41, -v7
  v_add_f32 v9, v9, v35
  v_mfma_f32_32x32x16_bf16 v[240:255], v[76:79], v[44:47], v[240:255]
  ds_read_b128 v[68:71], v2 offset:128
  v_add3_u32 v6, s46, v20, v0
  s_branch L_LOOP
.p2align 12
TAIL_1:
  s_cbranch_execz RETH_R3
  s_waitcnt lgkmcnt(6)
  v_mfma_f32_32x32x16_bf16 v[160:175], v[64:67], v[40:43], v[160:175]
  ds_read_b64_tr_b16 v[56:57], v5 offset:6144
  ds_read_b64_tr_b16 v[58:59], v5 offset:9216
  v_add_f32 v8, v8, v9
  s_add_u32 s48, s46, s47
  s_sub_u32 s49, s48, 147456
  v_mfma_f32_32x32x16_bf16 v[176:191], v[68:71], v[40:43], v[176:191]
  ds_read_b64_tr_b16 v[60:61], v6 offset:6208
  ds_read_b64_tr_b16 v[62:63], v6 offset:9280
  s_min_u32 s46, s48, s49
  v_mfma_f32_32x32x16_bf16 v[192:207], v[72:75], v[40:43], v[192:207]
  ds_read_b64_tr_b16 v[64:65], v5 offset:6272
  ds_read_b64_tr_b16 v[66:67], v5 offset:9344
  v_cndmask_b32 v80, v80, v13, s[56:57]
  v_cndmask_b32 v81, v81, v13, s[58:59]
  v_cndmask_b32 v82, v82, v13, s[60:61]
  v_cndmask_b32 v83, v83, v13, s[62:63]
  v_cndmask_b32 v84, v84, v13, s[64:65]
  v_cndmask_b32 v85, v85, v13, s[66:67]
  v_cndmask_b32 v86, v86, v13, s[68:69]
  v_cndmask_b32 v87, v87, v13, s[70:71]
  s_waitcnt lgkmcnt(6)
  v_mfma_f32_32x32x16_bf16 v[208:223], v[76:79], v[40:43], v[208:223]
  ds_read_b64_tr_b16 v[68:69], v6 offset:6336
  ds_read_b64_tr_b16 v[70:71], v6 offset:9408
  v_cndmask_b32 v88, v88, v13, s[72:73]
  v_cndmask_b32 v89, v89, v13, s[74:75]
  v_cndmask_b32 v90, v90, v13, s[76:77]
  v_cndmask_b32 v91, v91, v13, s[78:79]
  v_cndmask_b32 v92, v92, v13, s[80:81]
  v_cndmask_b32 v93, v93, v13, s[82:83]
  v_cndmask_b32 v94, v94, v13, s[84:85]
  v_cndmask_b32 v95, v95, v13, s[86:87]
  v_mfma_f32_32x32x16_bf16 v[224:239], v[48:51], v[40:43], v[224:239]
  ds_read_b64_tr_b16 v[72:73], v5 offset:6400
  ds_read_b64_tr_b16 v[74:75], v5 offset:9472
  v_max3_f32 v10, v80, v81, v82
  v_max3_f32 v11, v83, v84, v85
  v_max3_f32 v10, v10, v86, v87
  v_max3_f32 v11, v11, v88, v89
  v_max3_f32 v10, v10, v90, v91
  v_max3_f32 v11, v11, v92, v93
  v_max3_f32 v10, v10, v94, v95
  v_max_f32 v10, v10, v11
  v_fma_f32 v11, v10, s41, -v7
  v_mfma_f32_32x32x16_bf16 v[240:255], v[52:55], v[40:43], v[240:255]
  ds_read_b64_tr_b16 v[76:77], v6 offset:6464
  ds_read_b64_tr_b16 v[78:79], v6 offset:9536
  v_add3_u32 v5, s46, v19, v0
  v_add3_u32 v6, s46, v20, v0
  v_cmp_lt_f32 vcc, 0x41000000, v11
  s_cbranch_vccnz RARE1_T1
RET1_T1:
  v_fma_f32 v80, v80, s41, -v7
  v_fma_f32 v81, v81, s41, -v7
  v_fma_f32 v82, v82, s41, -v7
  s_waitcnt lgkmcnt(6)
  v_mfma_f32_32x32x16_bf16 v[160:175], v[56:59], v[44:47], v[160:175]
  s_barrier
  ds_read_b64_tr_b16 v[48:49], v5 offset:0
  ds_read_b64_tr_b16 v[50:51], v5 offset:3072
  v_fma_f32 v83, v83, s41, -v7
  v_exp_f32 v80, v80
  v_fma_f32 v84, v84, s41, -v7
  v_exp_f32 v81, v81
  v_mfma_f32_32x32x16_bf16 v[176:191], v[60:63], v[44:47], v[176:191]
  ds_read_b64_tr_b16 v[52:53], v6 offset:64
  ds_read_b64_tr_b16 v[54:55], v6 offset:3136
  v_fma_f32 v85, v85, s41, -v7
  v_exp_f32 v82, v82
  v_fma_f32 v86, v86, s41, -v7
  v_exp_f32 v83, v83
  v_fma_f32 v87, v87, s41, -v7
  v_add_f32 v8, v8, v80
  v_mfma_f32_32x32x16_bf16 v[192:207], v[64:67], v[44:47], v[192:207]
  ds_read_b64_tr_b16 v[56:57], v5 offset:128
  ds_read_b64_tr_b16 v[58:59], v5 offset:3200
  v_exp_f32 v84, v84
  v_fma_f32 v88, v88, s41, -v7
  v_add_f32 v8, v8, v81
  v_cvt_pk_bf16_f32 v40, v80, v81
  v_exp_f32 v85, v85
  v_fma_f32 v89, v89, s41, -v7
  s_waitcnt lgkmcnt(6)
  v_mfma_f32_32x32x16_bf16 v[208:223], v[68:71], v[44:47], v[208:223]
  ds_read_b64_tr_b16 v[60:61], v6 offset:192
  ds_read_b64_tr_b16 v[62:63], v6 offset:3264
  v_add_f32 v8, v8, v82
  v_exp_f32 v86, v86
  v_fma_f32 v90, v90, s41, -v7
  v_add_f32 v8, v8, v83
  v_cvt_pk_bf16_f32 v41, v82, v83
  v_exp_f32 v87, v87
  v_mfma_f32_32x32x16_bf16 v[224:239], v[72:75], v[44:47], v[224:239]
  ds_read_b64_tr_b16 v[64:65], v5 offset:256
  ds_read_b64_tr_b16 v[66:67], v5 offset:3328
  v_fma_f32 v91, v91, s41, -v7
  v_add_f32 v8, v8, v84
  v_exp_f32 v88, v88
  v_fma_f32 v92, v92, s41, -v7
  v_add_f32 v8, v8, v85
  v_cvt_pk_bf16_f32 v42, v84, v85
  v_exp_f32 v89, v89
  v_mfma_f32_32x32x16_bf16 v[240:255], v[76:79], v[44:47], v[240:255]
  ds_read_b64_tr_b16 v[68:69], v6 offset:320
  ds_read_b64_tr_b16 v[70:71], v6 offset:3392
  v_fma_f32 v93, v93, s41, -v7
  v_add_f32 v8, v8, v86
  v_exp_f32 v90, v90
  v_fma_f32 v94, v94, s41, -v7
  v_add_f32 v8, v8, v87
  v_cvt_pk_bf16_f32 v43, v86, v87
  s_cbranch_vccnz RARE2_T1
RET2_T1:
FIN_1:
  s_nop 1
  s_waitcnt lgkmcnt(6)
  v_mfma_f32_32x32x16_bf16 v[160:175], v[48:51], v[40:43], v[160:175]
  ds_read_b64_tr_b16 v[72:73], v5 offset:6144
  ds_read_b64_tr_b16 v[74:75], v5 offset:9216
  v_exp_f32 v91, v91
  v_fma_f32 v95, v95, s41, -v7
  v_add_f32 v8, v8, v88
  v_mfma_f32_32x32x16_bf16 v[176:191], v[52:55], v[40:43], v[176:191]
  ds_read_b64_tr_b16 v[76:77], v6 offset:6208
  ds_read_b64_tr_b16 v[78:79], v6 offset:9280
  v_exp_f32 v92, v92
  v_add_f32 v8, v8, v89
  v_cvt_pk_bf16_f32 v44, v88, v89
  v_exp_f32 v93, v93
  v_mfma_f32_32x32x16_bf16 v[192:207], v[56:59], v[40:43], v[192:207]
  ds_read_b64_tr_b16 v[48:49], v5 offset:6272
  ds_read_b64_tr_b16 v[50:51], v5 offset:9344
  v_add_f32 v8, v8, v90
  v_exp_f32 v94, v94
  s_waitcnt lgkmcnt(6)
  v_mfma_f32_32x32x16_bf16 v[208:223], v[60:63], v[40:43], v[208:223]
  ds_read_b64_tr_b16 v[52:53], v6 offset:6336
  ds_read_b64_tr_b16 v[54:55], v6 offset:9408
  v_add_f32 v8, v8, v91
  v_cvt_pk_bf16_f32 v45, v90, v91
  v_exp_f32 v95, v95
  v_add_f32 v8, v8, v92
  v_mfma_f32_32x32x16_bf16 v[224:239], v[64:67], v[40:43], v[224:239]
  ds_read_b64_tr_b16 v[56:57], v5 offset:6400
  ds_read_b64_tr_b16 v[58:59], v5 offset:9472
  v_add_f32 v8, v8, v93
  v_cvt_pk_bf16_f32 v46, v92, v93
  v_add_f32 v8, v8, v94
  v_add_f32 v8, v8, v95
  v_cvt_pk_bf16_f32 v47, v94, v95
  v_mfma_f32_32x32x16_bf16 v[240:255], v[68:71], v[40:43], v[240:255]
  ds_read_b64_tr_b16 v[60:61], v6 offset:6464
  ds_read_b64_tr_b16 v[62:63], v6 offset:9536
  s_mul_i32 s48, s45, 43
  s_lshr_b32 s48, s48, 8
  s_mul_i32 s48, s48, 6
  s_waitcnt lgkmcnt(6)
  v_mfma_f32_32x32x16_bf16 v[160:175], v[72:75], v[44:47], v[160:175]
  v_mov_b32 v12, v8
  s_sub_u32 s51, s45, s48
  s_bfe_u32 s3, s34, 0x10009
  s_add_u32 s50, s51, s52
  s_sub_u32 s48, s50, 6
  s_min_u32 s50, s50, s48
  v_mfma_f32_32x32x16_bf16 v[176:191], v[76:79], v[44:47], v[176:191]
  v_permlane32_swap_b32 v8, v12
  v_add_f32 v8, v8, v12
  s_mul_i32 s50, s50, 24576
  s_add_u32 s50, s50, s42
  v_add_u32 v96, s50, v21
  v_add_u32 v104, s50, v23
  v_mfma_f32_32x32x16_bf16 v[192:207], v[48:51], v[44:47], v[192:207]
  v_rcp_f32 v9, v8
  v_xor_b32 v97, 16, v96
  v_xor_b32 v98, 32, v96
  v_xor_b32 v99, 48, v96
  s_waitcnt lgkmcnt(0)
  v_mfma_f32_32x32x16_bf16 v[208:223], v[52:55], v[44:47], v[208:223]
  v_xor_b32 v100, 64, v96
  v_xor_b32 v101, 80, v96
  v_xor_b32 v102, 96, v96
  v_xor_b32 v103, 112, v96
  v_mfma_f32_32x32x16_bf16 v[224:239], v[56:59], v[44:47], v[224:239]
  v_mfma_f32_32x32x16_bf16 v[240:255], v[60:63], v[44:47], v[240:255]
  s_branch L_EPI
TAIL_0:
  s_cbranch_execz RETH_R4
  s_waitcnt lgkmcnt(6)
  v_mfma_f32_32x32x16_bf16 v[160:175], v[64:67], v[40:43], v[160:175]
  ds_read_b64_tr_b16 v[56:57], v5 offset:6144
  ds_read_b64_tr_b16 v[58:59], v5 offset:9216
  v_add_f32 v8, v8, v9
  s_add_u32 s48, s46, s47
  s_sub_u32 s49, s48, 147456
  v_mfma_f32_32x32x16_bf16 v[176:191], v[68:71], v[40:43], v[176:191]
  ds_read_b64_tr_b16 v[60:61], v6 offset:6208
  ds_read_b64_tr_b16 v[62:63], v6 offset:9280
  s_min_u32 s46, s48, s49
  v_mfma_f32_32x32x16_bf16 v[192:207], v[72:75], v[40:43], v[192:207]
  ds_read_b64_tr_b16 v[64:65], v5 offset:6272
  ds_read_b64_tr_b16 v[66:67], v5 offset:9344
  v_cndmask_b32 v96, v96, v13, s[56:57]
  v_cndmask_b32 v97, v97, v13, s[58:59]
  v_cndmask_b32 v98, v98, v13, s[60:61]
  v_cndmask_b32 v99, v99, v13, s[62:63]
  v_cndmask_b32 v100, v100, v13, s[64:65]
  v_cndmask_b32 v101, v101, v13, s[66:67]
  v_cndmask_b32 v102, v102, v13, s[68:69]
  v_cndmask_b32 v103, v103, v13, s[70:71]
  s_waitcnt lgkmcnt(6)
  v_mfma_f32_32x32x16_bf16 v[208:223], v[76:79], v[40:43], v[208:223]
  ds_read_b64_tr_b16 v[68:69], v6 offset:6336
  ds_read_b64_tr_b16 v[70:71], v6 offset:9408
  v_cndmask_b32 v104, v104, v13, s[72:73]
  v_cndmask_b32 v105, v105, v13, s[74:75]
  v_cndmask_b32 v106, v106, v13, s[76:77]
  v_cndmask_b32 v107, v107, v13, s[78:79]
  v_cndmask_b32 v108, v108, v13, s[80:81]
  v_cndmask_b32 v109, v109, v13, s[82:83]
  v_cndmask_b32 v110, v110, v13, s[84:85]
  v_cndmask_b32 v111, v111, v13, s[86:87]
  v_mfma_f32_32x32x16_bf16 v[224:239], v[48:51], v[40:43], v[224:239]
  ds_read_b64_tr_b16 v[72:73], v5 offset:6400
  ds_read_b64_tr_b16 v[74:75], v5 offset:9472
  v_max3_f32 v10, v96, v97, v98
  v_max3_f32 v11, v99, v100, v101
  v_max3_f32 v10, v10, v102, v103
  v_max3_f32 v11, v11, v104, v105
  v_max3_f32 v10, v10, v106, v107
  v_max3_f32 v11, v11, v108, v109
  v_max3_f32 v10, v10, v110, v111
  v_max_f32 v10, v10, v11
  v_fma_f32 v11, v10, s41, -v7
  v_mfma_f32_32x32x16_bf16 v[240:255], v[52:55], v[40:43], v[240:255]
  ds_read_b64_tr_b16 v[76:77], v6 offset:6464
  ds_read_b64_tr_b16 v[78:79], v6 offset:9536
  v_add3_u32 v5, s46, v19, v0
  v_add3_u32 v6, s46, v20, v0
  v_cmp_lt_f32 vcc, 0x41000000, v11
  s_cbranch_vccnz RARE1_T0
RET1_T0:
  v_fma_f32 v96, v96, s41, -v7
  v_fma_f32 v97, v97, s41, -v7
  v_fma_f32 v98, v98, s41, -v7
  s_waitcnt lgkmcnt(6)
  v_mfma_f32_32x32x16_bf16 v[160:175], v[56:59], v[44:47], v[160:175]
  s_barrier
  ds_read_b64_tr_b16 v[48:49], v5 offset:0
  ds_read_b64_tr_b16 v[50:51], v5 offset:3072
  v_fma_f32 v99, v99, s41, -v7
  v_exp_f32 v96, v96
  v_fma_f32 v100, v100, s41, -v7
  v_exp_f32 v97, v97
  v_mfma_f32_32x32x16_bf16 v[176:191], v[60:63], v[44:47], v[176:191]
  ds_read_b64_tr_b16 v[52:53], v6 offset:64
  ds_read_b64_tr_b16 v[54:55], v6 offset:3136
  v_fma_f32 v101, v101, s41, -v7
  v_exp_f32 v98, v98
  v_fma_f32 v102, v102, s41, -v7
  v_exp_f32 v99, v99
  v_fma_f32 v103, v103, s41, -v7
  v_add_f32 v8, v8, v96
  v_mfma_f32_32x32x16_bf16 v[192:207], v[64:67], v[44:47], v[192:207]
  ds_read_b64_tr_b16 v[56:57], v5 offset:128
  ds_read_b64_tr_b16 v[58:59], v5 offset:3200
  v_exp_f32 v100, v100
  v_fma_f32 v104, v104, s41, -v7
  v_add_f32 v8, v8, v97
  v_cvt_pk_bf16_f32 v40, v96, v97
  v_exp_f32 v101, v101
  v_fma_f32 v105, v105, s41, -v7
  s_waitcnt lgkmcnt(6)
  v_mfma_f32_32x32x16_bf16 v[208:223], v[68:71], v[44:47], v[208:223]
  ds_read_b64_tr_b16 v[60:61], v6 offset:192
  ds_read_b64_tr_b16 v[62:63], v6 offset:3264
  v_add_f32 v8, v8, v98
  v_exp_f32 v102, v102
  v_fma_f32 v106, v106, s41, -v7
  v_add_f32 v8, v8, v99
  v_cvt_pk_bf16_f32 v41, v98, v99
  v_exp_f32 v103, v103
  v_mfma_f32_32x32x16_bf16 v[224:239], v[72:75], v[44:47], v[224:239]
  ds_read_b64_tr_b16 v[64:65], v5 offset:256
  ds_read_b64_tr_b16 v[66:67], v5 offset:3328
  v_fma_f32 v107, v107, s41, -v7
  v_add_f32 v8, v8, v100
  v_exp_f32 v104, v104
  v_fma_f32 v108, v108, s41, -v7
  v_add_f32 v8, v8, v101
  v_cvt_pk_bf16_f32 v42, v100, v101
  v_exp_f32 v105, v105
  v_mfma_f32_32x32x16_bf16 v[240:255], v[76:79], v[44:47], v[240:255]
  ds_read_b64_tr_b16 v[68:69], v6 offset:320
  ds_read_b64_tr_b16 v[70:71], v6 offset:3392
  v_fma_f32 v109, v109, s41, -v7
  v_add_f32 v8, v8, v102
  v_exp_f32 v106, v106
  v_fma_f32 v110, v110, s41, -v7
  v_add_f32 v8, v8, v103
  v_cvt_pk_bf16_f32 v43, v102, v103
  s_cbranch_vccnz RARE2_T0
RET2_T0:
FIN_0:
  s_cbranch_execz RETH_RX
  s_nop 0
  s_waitcnt lgkmcnt(6)
  v_mfma_f32_32x32x16_bf16 v[160:175], v[48:51], v[40:43], v[160:175]
  ds_read_b64_tr_b16 v[72:73], v5 offset:6144
  ds_read_b64_tr_b16 v[74:75], v5 offset:9216
  v_exp_f32 v107, v107
  v_fma_f32 v111, v111, s41, -v7
  v_add_f32 v8, v8, v104
  v_mfma_f32_32x32x16_bf16 v[176:191], v[52:55], v[40:43], v[176:191]
  ds_read_b64_tr_b16 v[76:77], v6 offset:6208
  ds_read_b64_tr_b16 v[78:79], v6 offset:9280
  v_exp_f32 v108, v108
  v_add_f32 v8, v8, v105
  v_cvt_pk_bf16_f32 v44, v104, v105
  v_exp_f32 v109, v109
  v_mfma_f32_32x32x16_bf16 v[192:207], v[56:59], v[40:43], v[192:207]
  ds_read_b64_tr_b16 v[48:49], v5 offset:6272
  ds_read_b64_tr_b16 v[50:51], v5 offset:9344
  v_add_f32 v8, v8, v106
  v_exp_f32 v110, v110
  s_waitcnt lgkmcnt(6)
  v_mfma_f32_32x32x16_bf16 v[208:223], v[60:63], v[40:43], v[208:223]
  ds_read_b64_tr_b16 v[52:53], v6 offset:6336
  ds_read_b64_tr_b16 v[54:55], v6 offset:9408
  v_add_f32 v8, v8, v107
  v_cvt_pk_bf16_f32 v45, v106, v107
  v_exp_f32 v111, v111
  v_add_f32 v8, v8, v108
  v_mfma_f32_32x32x16_bf16 v[224:239], v[64:67], v[40:43], v[224:239]
  ds_read_b64_tr_b16 v[56:57], v5 offset:6400
  ds_read_b64_tr_b16 v[58:59], v5 offset:9472
  v_add_f32 v8, v8, v109
  v_cvt_pk_bf16_f32 v46, v108, v109
  v_add_f32 v8, v8, v110
  v_add_f32 v8, v8, v111
  v_cvt_pk_bf16_f32 v47, v110, v111
  v_mfma_f32_32x32x16_bf16 v[240:255], v[68:71], v[40:43], v[240:255]
  ds_read_b64_tr_b16 v[60:61], v6 offset:6464
  ds_read_b64_tr_b16 v[62:63], v6 offset:9536
  s_mul_i32 s48, s45, 43
  s_lshr_b32 s48, s48, 8
  s_mul_i32 s48, s48, 6
  s_waitcnt lgkmcnt(6)
  v_mfma_f32_32x32x16_bf16 v[160:175], v[72:75], v[44:47], v[160:175]
  v_mov_b32 v12, v8
  s_sub_u32 s51, s45, s48
  s_bfe_u32 s3, s34, 0x10009
  s_add_u32 s50, s51, s52
  s_sub_u32 s48, s50, 6
  s_min_u32 s50, s50, s48
  v_mfma_f32_32x32x16_bf16 v[176:191], v[76:79], v[44:47], v[176:191]
  v_permlane32_swap_b32 v8, v12
  v_add_f32 v8, v8, v12
  s_mul_i32 s50, s50, 24576
  s_add_u32 s50, s50, s42
  v_add_u32 v96, s50, v21
  v_add_u32 v104, s50, v23
  v_mfma_f32_32x32x16_bf16 v[192:207], v[48:51], v[44:47], v[192:207]
  v_rcp_f32 v9, v8
  v_xor_b32 v97, 16, v96
  v_xor_b32 v98, 32, v96
  v_xor_b32 v99, 48, v96
  s_waitcnt lgkmcnt(0)
  v_mfma_f32_32x32x16_bf16 v[208:223], v[52:55], v[44:47], v[208:223]
  v_xor_b32 v100, 64, v96
  v_xor_b32 v101, 80, v96
  v_xor_b32 v102, 96, v96
  v_xor_b32 v103, 112, v96
  v_mfma_f32_32x32x16_bf16 v[224:239], v[56:59], v[44:47], v[224:239]
  v_mfma_f32_32x32x16_bf16 v[240:255], v[60:63], v[44:47], v[240:255]
L_EPI:
  s_cbranch_execz RETH_RX
  s_cmp_eq_u32 s40, s39
  s_cbranch_scc1 L_NOXB
  s_barrier
L_NOXB:
  s_cmp_eq_u32 s38, 2
  s_cbranch_scc1 L_MERGE
  s_cmp_lg_u32 s3, 0
  s_cbranch_scc1 L_EG
  s_add_u32 s35, s44, 49152
  s_add_u32 s36, s44, s55
  s_add_u32 s37, s36, 49152
  v_pk_mul_f32 v[160:161], v[160:161], v[8:9] op_sel:[0,1] op_sel_hi:[1,1]
  v_pk_mul_f32 v[162:163], v[162:163], v[8:9] op_sel:[0,1] op_sel_hi:[1,1]
  v_pk_mul_f32 v[164:165], v[164:165], v[8:9] op_sel:[0,1] op_sel_hi:[1,1]
  v_pk_mul_f32 v[166:167], v[166:167], v[8:9] op_sel:[0,1] op_sel_hi:[1,1]
  v_cvt_pk_bf16_f32 v160, v160, v161
  v_cvt_pk_bf16_f32 v161, v162, v163
  v_pk_mul_f32 v[168:169], v[168:169], v[8:9] op_sel:[0,1] op_sel_hi:[1,1]
  v_pk_mul_f32 v[170:171], v[170:171], v[8:9] op_sel:[0,1] op_sel_hi:[1,1]
  v_cvt_pk_bf16_f32 v164, v164, v165
  v_cvt_pk_bf16_f32 v165, v166, v167
  ds_write_b64 v96, v[160:161] offset:0
  v_pk_mul_f32 v[172:173], v[172:173], v[8:9] op_sel:[0,1] op_sel_hi:[1,1]
  v_pk_mul_f32 v[174:175], v[174:175], v[8:9] op_sel:[0,1] op_sel_hi:[1,1]
  v_cvt_pk_bf16_f32 v168, v168, v169
  v_cvt_pk_bf16_f32 v169, v170, v171
  ds_write_b64 v97, v[164:165] offset:0
  v_pk_mul_f32 v[176:177], v[176:177], v[8:9] op_sel:[0,1] op_sel_hi:[1,1]
  v_pk_mul_f32 v[178:179], v[178:179], v[8:9] op_sel:[0,1] op_sel_hi:[1,1]
  v_cvt_pk_bf16_f32 v172, v172, v173
  v_cvt_pk_bf16_f32 v173, v174, v175
  ds_write_b64 v98, v[168:169] offset:0
  v_pk_mul_f32 v[180:181], v[180:181], v[8:9] op_sel:[0,1] op_sel_hi:[1,1]
  v_pk_mul_f32 v[182:183], v[182:183], v[8:9] op_sel:[0,1] op_sel_hi:[1,1]
  v_cvt_pk_bf16_f32 v176, v176, v177
  v_cvt_pk_bf16_f32 v177, v178, v179
  ds_write_b64 v99, v[172:173] offset:0
  v_pk_mul_f32 v[184:185], v[184:185], v[8:9] op_sel:[0,1] op_sel_hi:[1,1]
  v_pk_mul_f32 v[186:187], v[186:187], v[8:9] op_sel:[0,1] op_sel_hi:[1,1]
  v_cvt_pk_bf16_f32 v180, v180, v181
  v_cvt_pk_bf16_f32 v181, v182, v183
  ds_write_b64 v100, v[176:177] offset:0
  v_pk_mul_f32 v[188:189], v[188:189], v[8:9] op_sel:[0,1] op_sel_hi:[1,1]
  v_pk_mul_f32 v[190:191], v[190:191], v[8:9] op_sel:[0,1] op_sel_hi:[1,1]
  v_cvt_pk_bf16_f32 v184, v184, v185
  v_cvt_pk_bf16_f32 v185, v186, v187
  ds_write_b64 v101, v[180:181] offset:0
  v_pk_mul_f32 v[192:193], v[192:193], v[8:9] op_sel:[0,1] op_sel_hi:[1,1]
  v_pk_mul_f32 v[194:195], v[194:195], v[8:9] op_sel:[0,1] op_sel_hi:[1,1]
  v_cvt_pk_bf16_f32 v188, v188, v189
  v_cvt_pk_bf16_f32 v189, v190, v191
  ds_write_b64 v102, v[184:185] offset:0
  v_pk_mul_f32 v[196:197], v[196:197], v[8:9] op_sel:[0,1] op_sel_hi:[1,1]
  v_pk_mul_f32 v[198:199], v[198:199], v[8:9] op_sel:[0,1] op_sel_hi:[1,1]
  v_cvt_pk_bf16_f32 v192, v192, v193
  v_cvt_pk_bf16_f32 v193, v194, v195
  ds_write_b64 v103, v[188:189] offset:0
  ds_read_b128 v[48:51], v104 offset:0
  ds_read_b128 v[52:55], v104 offset:3072
  ds_read_b128 v[56:59], v104 offset:6144
  ds_read_b128 v[60:63], v104 offset:9216
  v_pk_mul_f32 v[200:201], v[200:201], v[8:9] op_sel:[0,1] op_sel_hi:[1,1]
  v_pk_mul_f32 v[202:203], v[202:203], v[8:9] op_sel:[0,1] op_sel_hi:[1,1]
  v_cvt_pk_bf16_f32 v196, v196, v197
  v_cvt_pk_bf16_f32 v197, v198, v199
  ds_write_b64 v96, v[192:193] offset:128
  v_pk_mul_f32 v[204:205], v[204:205], v[8:9] op_sel:[0,1] op_sel_hi:[1,1]
  v_pk_mul_f32 v[206:207], v[206:207], v[8:9] op_sel:[0,1] op_sel_hi:[1,1]
  v_cvt_pk_bf16_f32 v200, v200, v201
  v_cvt_pk_bf16_f32 v201, v202, v203
  ds_write_b64 v97, v[196:197] offset:128
  s_waitcnt lgkmcnt(5)
  buffer_store_dwordx4 v[48:51], v24, s[28:31], s44 offen offset:0 sc0 sc1 nt
  v_pk_mul_f32 v[208:209], v[208:209], v[8:9] op_sel:[0,1] op_sel_hi:[1,1]
  v_pk_mul_f32 v[210:211], v[210:211], v[8:9] op_sel:[0,1] op_sel_hi:[1,1]
  v_cvt_pk_bf16_f32 v204, v204, v205
  v_cvt_pk_bf16_f32 v205, v206, v207
  ds_write_b64 v98, v[200:201] offset:128
  s_waitcnt lgkmcnt(5)
  buffer_store_dwordx4 v[52:55], v25, s[28:31], s35 offen offset:0 sc0 sc1 nt
  v_pk_mul_f32 v[212:213], v[212:213], v[8:9] op_sel:[0,1] op_sel_hi:[1,1]
  v_pk_mul_f32 v[214:215], v[214:215], v[8:9] op_sel:[0,1] op_sel_hi:[1,1]
  v_cvt_pk_bf16_f32 v208, v208, v209
  v_cvt_pk_bf16_f32 v209, v210, v211
  ds_write_b64 v99, v[204:205] offset:128
  s_waitcnt lgkmcnt(5)
  buffer_store_dwordx4 v[56:59], v24, s[28:31], s36 offen offset:0 sc0 sc1 nt
  v_pk_mul_f32 v[216:217], v[216:217], v[8:9] op_sel:[0,1] op_sel_hi:[1,1]
  v_pk_mul_f32 v[218:219], v[218:219], v[8:9] op_sel:[0,1] op_sel_hi:[1,1]
  v_cvt_pk_bf16_f32 v212, v212, v213
  v_cvt_pk_bf16_f32 v213, v214, v215
  ds_write_b64 v100, v[208:209] offset:128
  s_waitcnt lgkmcnt(5)
  buffer_store_dwordx4 v[60:63], v25, s[28:31], s37 offen offset:0 sc0 sc1 nt
  v_pk_mul_f32 v[220:221], v[220:221], v[8:9] op_sel:[0,1] op_sel_hi:[1,1]
  v_pk_mul_f32 v[222:223], v[222:223], v[8:9] op_sel:[0,1] op_sel_hi:[1,1]
  v_cvt_pk_bf16_f32 v216, v216, v217
  v_cvt_pk_bf16_f32 v217, v218, v219
  ds_write_b64 v101, v[212:213] offset:128
  v_pk_mul_f32 v[224:225], v[224:225], v[8:9] op_sel:[0,1] op_sel_hi:[1,1]
  v_pk_mul_f32 v[226:227], v[226:227], v[8:9] op_sel:[0,1] op_sel_hi:[1,1]
  v_cvt_pk_bf16_f32 v220, v220, v221
  v_cvt_pk_bf16_f32 v221, v222, v223
  ds_write_b64 v102, v[216:217] offset:128
  v_pk_mul_f32 v[228:229], v[228:229], v[8:9] op_sel:[0,1] op_sel_hi:[1,1]
  v_pk_mul_f32 v[230:231], v[230:231], v[8:9] op_sel:[0,1] op_sel_hi:[1,1]
  v_cvt_pk_bf16_f32 v224, v224, v225
  v_cvt_pk_bf16_f32 v225, v226, v227
  ds_write_b64 v103, v[220:221] offset:128
  ds_read_b128 v[64:67], v104 offset:128
  ds_read_b128 v[68:71], v104 offset:3200
  ds_read_b128 v[72:75], v104 offset:6272
  ds_read_b128 v[76:79], v104 offset:9344
  v_pk_mul_f32 v[232:233], v[232:233], v[8:9] op_sel:[0,1] op_sel_hi:[1,1]
  v_pk_mul_f32 v[234:235], v[234:235], v[8:9] op_sel:[0,1] op_sel_hi:[1,1]
  v_cvt_pk_bf16_f32 v228, v228, v229
  v_cvt_pk_bf16_f32 v229, v230, v231
  ds_write_b64 v96, v[224:225] offset:256
  v_pk_mul_f32 v[236:237], v[236:237], v[8:9] op_sel:[0,1] op_sel_hi:[1,1]
  v_pk_mul_f32 v[238:239], v[238:239], v[8:9] op_sel:[0,1] op_sel_hi:[1,1]
  v_cvt_pk_bf16_f32 v232, v232, v233
  v_cvt_pk_bf16_f32 v233, v234, v235
  ds_write_b64 v97, v[228:229] offset:256
  s_waitcnt lgkmcnt(5)
  buffer_store_dwordx4 v[64:67], v24, s[28:31], s44 offen offset:128 sc0 sc1 nt
  v_pk_mul_f32 v[240:241], v[240:241], v[8:9] op_sel:[0,1] op_sel_hi:[1,1]
  v_pk_mul_f32 v[242:243], v[242:243], v[8:9] op_sel:[0,1] op_sel_hi:[1,1]
  v_cvt_pk_bf16_f32 v236, v236, v237
  v_cvt_pk_bf16_f32 v237, v238, v239
  ds_write_b64 v98, v[232:233] offset:256
  s_waitcnt lgkmcnt(5)
  buffer_store_dwordx4 v[68:71], v25, s[28:31], s35 offen offset:128 sc0 sc1 nt
  v_pk_mul_f32 v[244:245], v[244:245], v[8:9] op_sel:[0,1] op_sel_hi:[1,1]
  v_pk_mul_f32 v[246:247], v[246:247], v[8:9] op_sel:[0,1] op_sel_hi:[1,1]
  v_cvt_pk_bf16_f32 v240, v240, v241
  v_cvt_pk_bf16_f32 v241, v242, v243
  ds_write_b64 v99, v[236:237] offset:256
  s_waitcnt lgkmcnt(5)
  buffer_store_dwordx4 v[72:75], v24, s[28:31], s36 offen offset:128 sc0 sc1 nt
  v_pk_mul_f32 v[248:249], v[248:249], v[8:9] op_sel:[0,1] op_sel_hi:[1,1]
  v_pk_mul_f32 v[250:251], v[250:251], v[8:9] op_sel:[0,1] op_sel_hi:[1,1]
  v_cvt_pk_bf16_f32 v244, v244, v245
  v_cvt_pk_bf16_f32 v245, v246, v247
  ds_write_b64 v100, v[240:241] offset:256
  s_waitcnt lgkmcnt(5)
  buffer_store_dwordx4 v[76:79], v25, s[28:31], s37 offen offset:128 sc0 sc1 nt
  v_pk_mul_f32 v[252:253], v[252:253], v[8:9] op_sel:[0,1] op_sel_hi:[1,1]
  v_pk_mul_f32 v[254:255], v[254:255], v[8:9] op_sel:[0,1] op_sel_hi:[1,1]
  v_cvt_pk_bf16_f32 v248, v248, v249
  v_cvt_pk_bf16_f32 v249, v250, v251
  ds_write_b64 v101, v[244:245] offset:256
  v_cvt_pk_bf16_f32 v252, v252, v253
  v_cvt_pk_bf16_f32 v253, v254, v255
  ds_write_b64 v102, v[248:249] offset:256
  ds_write_b64 v103, v[252:253] offset:256
  ds_read_b128 v[80:83], v104 offset:256
  ds_read_b128 v[84:87], v104 offset:3328
  ds_read_b128 v[88:91], v104 offset:6400
  ds_read_b128 v[92:95], v104 offset:9472
  s_waitcnt lgkmcnt(3)
  buffer_store_dwordx4 v[80:83], v24, s[28:31], s44 offen offset:256 sc0 sc1 nt
  s_waitcnt lgkmcnt(2)
  buffer_store_dwordx4 v[84:87], v25, s[28:31], s35 offen offset:256 sc0 sc1 nt
  s_waitcnt lgkmcnt(1)
  buffer_store_dwordx4 v[88:91], v24, s[28:31], s36 offen offset:256 sc0 sc1 nt
  s_waitcnt lgkmcnt(0)
  buffer_store_dwordx4 v[92:95], v25, s[28:31], s37 offen offset:256 sc0 sc1 nt
L_DONE:
L_END:
  s_endpgm
.p2align 12
L_EG:
  s_cbranch_execz RETH_R6
  v_add_u32 v32, s50, v15
  v_add_u32 v33, s50, v16
  v_add_u32 v34, s50, v17
  v_add_u32 v35, s50, v18
  v_add_u32 v1, s20, v15
  v_add_u32 v2, s20, v16
  v_add_u32 v3, s20, v17
  v_add_u32 v4, s20, v18
  s_mov_b32 s44, s16
  s_mov_b32 s30, s17
  s_mov_b32 s40, s19
  s_mov_b32 s46, s21
  s_mov_b32 s45, s24
  s_mov_b32 s39, s26
  s_mov_b32 s34, 0
  ds_read_b128 v[112:115], v32 offset:0
  ds_read_b128 v[64:67], v1 offset:0
  v_pk_mul_f32 v[160:161], v[160:161], v[8:9] op_sel:[0,1] op_sel_hi:[1,1]
  v_pk_mul_f32 v[162:163], v[162:163], v[8:9] op_sel:[0,1] op_sel_hi:[1,1]
  ds_read_b128 v[116:119], v33 offset:0
  ds_read_b128 v[68:71], v2 offset:0
  v_pk_mul_f32 v[164:165], v[164:165], v[8:9] op_sel:[0,1] op_sel_hi:[1,1]
  v_pk_mul_f32 v[166:167], v[166:167], v[8:9] op_sel:[0,1] op_sel_hi:[1,1]
  ds_read_b128 v[120:123], v34 offset:0
  ds_read_b128 v[72:75], v3 offset:0
  v_pk_mul_f32 v[168:169], v[168:169], v[8:9] op_sel:[0,1] op_sel_hi:[1,1]
  v_pk_mul_f32 v[170:171], v[170:171], v[8:9] op_sel:[0,1] op_sel_hi:[1,1]
  ds_read_b128 v[124:127], v35 offset:0
  ds_read_b128 v[76:79], v4 offset:0
  v_pk_mul_f32 v[172:173], v[172:173], v[8:9] op_sel:[0,1] op_sel_hi:[1,1]
  v_pk_mul_f32 v[174:175], v[174:175], v[8:9] op_sel:[0,1] op_sel_hi:[1,1]
  ds_read_b128 v[128:131], v32 offset:128
  ds_read_b128 v[48:51], v1 offset:128
  v_pk_mul_f32 v[176:177], v[176:177], v[8:9] op_sel:[0,1] op_sel_hi:[1,1]
  v_pk_mul_f32 v[178:179], v[178:179], v[8:9] op_sel:[0,1] op_sel_hi:[1,1]
  ds_read_b128 v[132:135], v33 offset:128
  ds_read_b128 v[52:55], v2 offset:128
  v_pk_mul_f32 v[180:181], v[180:181], v[8:9] op_sel:[0,1] op_sel_hi:[1,1]
  v_pk_mul_f32 v[182:183], v[182:183], v[8:9] op_sel:[0,1] op_sel_hi:[1,1]
  ds_read_b128 v[136:139], v34 offset:128
  ds_read_b128 v[140:143], v35 offset:128
  v_pk_mul_f32 v[184:185], v[184:185], v[8:9] op_sel:[0,1] op_sel_hi:[1,1]
  v_pk_mul_f32 v[186:187], v[186:187], v[8:9] op_sel:[0,1] op_sel_hi:[1,1]
  ds_read_b128 v[144:147], v32 offset:256
  ds_read_b128 v[148:151], v33 offset:256
  v_pk_mul_f32 v[188:189], v[188:189], v[8:9] op_sel:[0,1] op_sel_hi:[1,1]
  v_pk_mul_f32 v[190:191], v[190:191], v[8:9] op_sel:[0,1] op_sel_hi:[1,1]
  ds_read_b128 v[152:155], v34 offset:256
  ds_read_b128 v[156:159], v35 offset:256
  v_pk_mul_f32 v[192:193], v[192:193], v[8:9] op_sel:[0,1] op_sel_hi:[1,1]
  v_pk_mul_f32 v[194:195], v[194:195], v[8:9] op_sel:[0,1] op_sel_hi:[1,1]
  s_sub_u32 s43, s40, 2
  v_pk_mul_f32 v[196:197], v[196:197], v[8:9] op_sel:[0,1] op_sel_hi:[1,1]
  v_pk_mul_f32 v[198:199], v[198:199], v[8:9] op_sel:[0,1] op_sel_hi:[1,1]
  v_pk_mul_f32 v[200:201], v[200:201], v[8:9] op_sel:[0,1] op_sel_hi:[1,1]
  v_pk_mul_f32 v[202:203], v[202:203], v[8:9] op_sel:[0,1] op_sel_hi:[1,1]
  v_pk_mul_f32 v[204:205], v[204:205], v[8:9] op_sel:[0,1] op_sel_hi:[1,1]
  v_pk_mul_f32 v[206:207], v[206:207], v[8:9] op_sel:[0,1] op_sel_hi:[1,1]
  v_pk_mul_f32 v[208:209], v[208:209], v[8:9] op_sel:[0,1] op_sel_hi:[1,1]
  v_pk_mul_f32 v[210:211], v[210:211], v[8:9] op_sel:[0,1] op_sel_hi:[1,1]
  v_pk_mul_f32 v[212:213], v[212:213], v[8:9] op_sel:[0,1] op_sel_hi:[1,1]
  v_pk_mul_f32 v[214:215], v[214:215], v[8:9] op_sel:[0,1] op_sel_hi:[1,1]
  v_pk_mul_f32 v[216:217], v[216:217], v[8:9] op_sel:[0,1] op_sel_hi:[1,1]
  v_pk_mul_f32 v[218:219], v[218:219], v[8:9] op_sel:[0,1] op_sel_hi:[1,1]
  v_pk_mul_f32 v[220:221], v[220:221], v[8:9] op_sel:[0,1] op_sel_hi:[1,1]
  v_pk_mul_f32 v[222:223], v[222:223], v[8:9] op_sel:[0,1] op_sel_hi:[1,1]
  v_pk_mul_f32 v[224:225], v[224:225], v[8:9] op_sel:[0,1] op_sel_hi:[1,1]
  v_pk_mul_f32 v[226:227], v[226:227], v[8:9] op_sel:[0,1] op_sel_hi:[1,1]
  v_pk_mul_f32 v[228:229], v[228:229], v[8:9] op_sel:[0,1] op_sel_hi:[1,1]
  v_pk_mul_f32 v[230:231], v[230:231], v[8:9] op_sel:[0,1] op_sel_hi:[1,1]
  v_pk_mul_f32 v[232:233], v[232:233], v[8:9] op_sel:[0,1] op_sel_hi:[1,1]
  v_pk_mul_f32 v[234:235], v[234:235], v[8:9] op_sel:[0,1] op_sel_hi:[1,1]
  v_pk_mul_f32 v[236:237], v[236:237], v[8:9] op_sel:[0,1] op_sel_hi:[1,1]
  v_pk_mul_f32 v[238:239], v[238:239], v[8:9] op_sel:[0,1] op_sel_hi:[1,1]
  v_pk_mul_f32 v[240:241], v[240:241], v[8:9] op_sel:[0,1] op_sel_hi:[1,1]
  v_pk_mul_f32 v[242:243], v[242:243], v[8:9] op_sel:[0,1] op_sel_hi:[1,1]
  v_pk_mul_f32 v[244:245], v[244:245], v[8:9] op_sel:[0,1] op_sel_hi:[1,1]
  v_pk_mul_f32 v[246:247], v[246:247], v[8:9] op_sel:[0,1] op_sel_hi:[1,1]
  v_pk_mul_f32 v[248:249], v[248:249], v[8:9] op_sel:[0,1] op_sel_hi:[1,1]
  v_pk_mul_f32 v[250:251], v[250:251], v[8:9] op_sel:[0,1] op_sel_hi:[1,1]
  v_pk_mul_f32 v[252:253], v[252:253], v[8:9] op_sel:[0,1] op_sel_hi:[1,1]
  v_pk_mul_f32 v[254:255], v[254:255], v[8:9] op_sel:[0,1] op_sel_hi:[1,1]
  v_cvt_pk_bf16_f32 v160, v160, v161
  v_cvt_pk_bf16_f32 v161, v162, v163
  v_cvt_pk_bf16_f32 v164, v164, v165
  s_waitcnt lgkmcnt(14)
  v_mfma_f32_32x32x16_bf16 v[80:95], v[64:67], v[112:115], 0
  ds_read_b128 v[56:59], v3 offset:128
  v_cvt_pk_bf16_f32 v165, v166, v167
  ds_write_b64 v96, v[160:161] offset:0
  v_cvt_pk_bf16_f32 v168, v168, v169
  v_cvt_pk_bf16_f32 v169, v170, v171
  ds_write_b64 v97, v[164:165] offset:0
  v_cvt_pk_bf16_f32 v172, v172, v173
  v_mfma_f32_32x32x16_bf16 v[80:95], v[68:71], v[116:119], v[80:95]
  ds_read_b128 v[60:63], v4 offset:128
  v_cvt_pk_bf16_f32 v173, v174, v175
  ds_write_b64 v98, v[168:169] offset:0
  v_cvt_pk_bf16_f32 v176, v176, v177
  v_cvt_pk_bf16_f32 v177, v178, v179
  ds_write_b64 v99, v[172:173] offset:0
  v_cvt_pk_bf16_f32 v180, v180, v181
  s_waitcnt lgkmcnt(15)
  v_mfma_f32_32x32x16_bf16 v[80:95], v[72:75], v[120:123], v[80:95]
  ds_read_b128 v[64:67], v1 offset:256
  v_cvt_pk_bf16_f32 v181, v182, v183
  ds_write_b64 v100, v[176:177] offset:0
  v_cvt_pk_bf16_f32 v184, v184, v185
  v_cvt_pk_bf16_f32 v185, v186, v187
  ds_write_b64 v101, v[180:181] offset:0
  v_cvt_pk_bf16_f32 v188, v188, v189
  v_mfma_f32_32x32x16_bf16 v[80:95], v[76:79], v[124:127], v[80:95]
  ds_read_b128 v[68:71], v2 offset:256
  v_cvt_pk_bf16_f32 v189, v190, v191
  ds_write_b64 v102, v[184:185] offset:0
  v_cvt_pk_bf16_f32 v192, v192, v193
  v_cvt_pk_bf16_f32 v193, v194, v195
  ds_write_b64 v103, v[188:189] offset:0
  s_waitcnt lgkmcnt(15)
  v_mfma_f32_32x32x16_bf16 v[80:95], v[48:51], v[128:131], v[80:95]
  ds_read_b128 v[72:75], v3 offset:256
  v_cvt_pk_bf16_f32 v196, v196, v197
  v_cvt_pk_bf16_f32 v197, v198, v199
  ds_write_b64 v96, v[192:193] offset:128
  v_cvt_pk_bf16_f32 v200, v200, v201
  v_cvt_pk_bf16_f32 v201, v202, v203
  ds_write_b64 v97, v[196:197] offset:128
  v_mfma_f32_32x32x16_bf16 v[80:95], v[52:55], v[132:135], v[80:95]
  ds_read_b128 v[76:79], v4 offset:256
  v_cvt_pk_bf16_f32 v204, v204, v205
  v_cvt_pk_bf16_f32 v205, v206, v207
  ds_write_b64 v98, v[200:201] offset:128
  v_cvt_pk_bf16_f32 v208, v208, v209
  v_cvt_pk_bf16_f32 v209, v210, v211
  ds_write_b64 v99, v[204:205] offset:128
  s_waitcnt lgkmcnt(14)
  v_mfma_f32_32x32x16_bf16 v[80:95], v[56:59], v[136:139], v[80:95]
  v_add_u32 v1, s46, v15
  v_add_u32 v2, s46, v16
  v_add_u32 v3, s46, v17
  v_add_u32 v4, s46, v18
  v_cvt_pk_bf16_f32 v212, v212, v213
  v_cvt_pk_bf16_f32 v213, v214, v215
  ds_write_b64 v100, v[208:209] offset:128
  v_mfma_f32_32x32x16_bf16 v[80:95], v[60:63], v[140:143], v[80:95]
  v_add3_u32 v5, s46, v19, v0
  v_add3_u32 v6, s46, v20, v0
  v_cvt_pk_bf16_f32 v216, v216, v217
  v_cvt_pk_bf16_f32 v217, v218, v219
  ds_write_b64 v101, v[212:213] offset:128
  v_cvt_pk_bf16_f32 v220, v220, v221
  s_waitcnt lgkmcnt(10)
  v_mfma_f32_32x32x16_bf16 v[80:95], v[64:67], v[144:147], v[80:95]
  v_cvt_pk_bf16_f32 v221, v222, v223
  ds_write_b64 v102, v[216:217] offset:128
  v_cvt_pk_bf16_f32 v224, v224, v225
  v_cvt_pk_bf16_f32 v225, v226, v227
  ds_write_b64 v103, v[220:221] offset:128
  v_cvt_pk_bf16_f32 v228, v228, v229
  v_cvt_pk_bf16_f32 v229, v230, v231
  v_mfma_f32_32x32x16_bf16 v[80:95], v[68:71], v[148:151], v[80:95]
  ds_write_b64 v96, v[224:225] offset:256
  v_cvt_pk_bf16_f32 v232, v232, v233
  v_cvt_pk_bf16_f32 v233, v234, v235
  ds_write_b64 v97, v[228:229] offset:256
  v_cvt_pk_bf16_f32 v236, v236, v237
  v_cvt_pk_bf16_f32 v237, v238, v239
  ds_write_b64 v98, v[232:233] offset:256
  s_waitcnt lgkmcnt(9)
  v_mfma_f32_32x32x16_bf16 v[80:95], v[72:75], v[152:155], v[80:95]
  v_cvt_pk_bf16_f32 v240, v240, v241
  v_cvt_pk_bf16_f32 v241, v242, v243
  ds_write_b64 v99, v[236:237] offset:256
  v_cvt_pk_bf16_f32 v244, v244, v245
  v_cvt_pk_bf16_f32 v245, v246, v247
  ds_write_b64 v100, v[240:241] offset:256
  v_cvt_pk_bf16_f32 v248, v248, v249
  v_mfma_f32_32x32x16_bf16 v[80:95], v[76:79], v[156:159], v[80:95]
  v_cvt_pk_bf16_f32 v249, v250, v251
  ds_write_b64 v101, v[244:245] offset:256
  v_cvt_pk_bf16_f32 v252, v252, v253
  v_cvt_pk_bf16_f32 v253, v254, v255
  ds_write_b64 v102, v[248:249] offset:256
  ds_write_b64 v103, v[252:253] offset:256
  v_mov_b32 v8, 0
  v_mov_b32 v7, 0
  s_waitcnt lgkmcnt(0)
  s_barrier
  ds_read_b128 v[48:51], v1 offset:0
  ds_read_b128 v[52:55], v2 offset:0
  ds_read_b128 v[56:59], v3 offset:0
  ds_read_b128 v[60:63], v4 offset:0
  ds_read_b128 v[64:67], v1 offset:128
  ds_read_b128 v[68:71], v2 offset:128
  s_cmp_gt_u32 s40, 1
  s_cbranch_scc1 L_AF
  s_cmp_eq_u32 s40, 1
  s_cbranch_scc1 L_ONE
  s_sub_u32 s43, s39, 1
  s_mov_b32 s3, 0
  s_branch L_IDLE1
TAIL_0z:
  s_cbranch_execz RETH_R5
  s_waitcnt lgkmcnt(6)
  v_mfma_f32_32x32x16_bf16 v[160:175], v[64:67], v[40:43], 0
  ds_read_b64_tr_b16 v[56:57], v5 offset:6144
  ds_read_b64_tr_b16 v[58:59], v5 offset:9216
  v_add_f32 v8, v8, v9
  s_add_u32 s48, s46, s47
  s_sub_u32 s49, s48, 147456
  v_mfma_f32_32x32x16_bf16 v[176:191], v[68:71], v[40:43], 0
  ds_read_b64_tr_b16 v[60:61], v6 offset:6208
  ds_read_b64_tr_b16 v[62:63], v6 offset:9280
  s_min_u32 s46, s48, s49
  v_mfma_f32_32x32x16_bf16 v[192:207], v[72:75], v[40:43], 0
  ds_read_b64_tr_b16 v[64:65], v5 offset:6272
  ds_read_b64_tr_b16 v[66:67], v5 offset:9344
  v_cndmask_b32 v96, v96, v13, s[56:57]
  v_cndmask_b32 v97, v97, v13, s[58:59]
  v_cndmask_b32 v98, v98, v13, s[60:61]
  v_cndmask_b32 v99, v99, v13, s[62:63]
  v_cndmask_b32 v100, v100, v13, s[64:65]
  v_cndmask_b32 v101, v101, v13, s[66:67]
  v_cndmask_b32 v102, v102, v13, s[68:69]
  v_cndmask_b32 v103, v103, v13, s[70:71]
  s_waitcnt lgkmcnt(6)
  v_mfma_f32_32x32x16_bf16 v[208:223], v[76:79], v[40:43], 0
  ds_read_b64_tr_b16 v[68:69], v6 offset:6336
  ds_read_b64_tr_b16 v[70:71], v6 offset:9408
  v_cndmask_b32 v104, v104, v13, s[72:73]
  v_cndmask_b32 v105, v105, v13, s[74:75]
  v_cndmask_b32 v106, v106, v13, s[76:77]
  v_cndmask_b32 v107, v107, v13, s[78:79]
  v_cndmask_b32 v108, v108, v13, s[80:81]
  v_cndmask_b32 v109, v109, v13, s[82:83]
  v_cndmask_b32 v110, v110, v13, s[84:85]
  v_cndmask_b32 v111, v111, v13, s[86:87]
  v_mfma_f32_32x32x16_bf16 v[224:239], v[48:51], v[40:43], 0
  ds_read_b64_tr_b16 v[72:73], v5 offset:6400
  ds_read_b64_tr_b16 v[74:75], v5 offset:9472
  v_max3_f32 v10, v96, v97, v98
  v_max3_f32 v11, v99, v100, v101
  v_max3_f32 v10, v10, v102, v103
  v_max3_f32 v11, v11, v104, v105
  v_max3_f32 v10, v10, v106, v107
  v_max3_f32 v11, v11, v108, v109
  v_max3_f32 v10, v10, v110, v111
  v_max_f32 v10, v10, v11
  v_fma_f32 v11, v10, s41, -v7
  v_mfma_f32_32x32x16_bf16 v[240:255], v[52:55], v[40:43], 0
  ds_read_b64_tr_b16 v[76:77], v6 offset:6464
  ds_read_b64_tr_b16 v[78:79], v6 offset:9536
  v_add3_u32 v5, s46, v19, v0
  v_add3_u32 v6, s46, v20, v0
  v_cmp_lt_f32 vcc, 0x41000000, v11
  s_cbranch_vccnz RARE1_T0z
RET1_T0z:
  v_fma_f32 v96, v96, s41, -v7
  v_fma_f32 v97, v97, s41, -v7
  v_fma_f32 v98, v98, s41, -v7
  s_waitcnt lgkmcnt(6)
  v_mfma_f32_32x32x16_bf16 v[160:175], v[56:59], v[44:47], v[160:175]
  s_barrier
  ds_read_b64_tr_b16 v[48:49], v5 offset:0
  ds_read_b64_tr_b16 v[50:51], v5 offset:3072
  v_fma_f32 v99, v99, s41, -v7
  v_exp_f32 v96, v96
  v_fma_f32 v100, v100, s41, -v7
  v_exp_f32 v97, v97
  v_mfma_f32_32x32x16_bf16 v[176:191], v[60:63], v[44:47], v[176:191]
  ds_read_b64_tr_b16 v[52:53], v6 offset:64
  ds_read_b64_tr_b16 v[54:55], v6 offset:3136
  v_fma_f32 v101, v101, s41, -v7
  v_exp_f32 v98, v98
  v_fma_f32 v102, v102, s41, -v7
  v_exp_f32 v99, v99
  v_fma_f32 v103, v103, s41, -v7
  v_add_f32 v8, v8, v96
  v_mfma_f32_32x32x16_bf16 v[192:207], v[64:67], v[44:47], v[192:207]
  ds_read_b64_tr_b16 v[56:57], v5 offset:128
  ds_read_b64_tr_b16 v[58:59], v5 offset:3200
  v_exp_f32 v100, v100
  v_fma_f32 v104, v104, s41, -v7
  v_add_f32 v8, v8, v97
  v_cvt_pk_bf16_f32 v40, v96, v97
  v_exp_f32 v101, v101
  v_fma_f32 v105, v105, s41, -v7
  s_waitcnt lgkmcnt(6)
  v_mfma_f32_32x32x16_bf16 v[208:223], v[68:71], v[44:47], v[208:223]
  ds_read_b64_tr_b16 v[60:61], v6 offset:192
  ds_read_b64_tr_b16 v[62:63], v6 offset:3264
  v_add_f32 v8, v8, v98
  v_exp_f32 v102, v102
  v_fma_f32 v106, v106, s41, -v7
  v_add_f32 v8, v8, v99
  v_cvt_pk_bf16_f32 v41, v98, v99
  v_exp_f32 v103, v103
  v_mfma_f32_32x32x16_bf16 v[224:239], v[72:75], v[44:47], v[224:239]
  ds_read_b64_tr_b16 v[64:65], v5 offset:256
  ds_read_b64_tr_b16 v[66:67], v5 offset:3328
  v_fma_f32 v107, v107, s41, -v7
  v_add_f32 v8, v8, v100
  v_exp_f32 v104, v104
  v_fma_f32 v108, v108, s41, -v7
  v_add_f32 v8, v8, v101
  v_cvt_pk_bf16_f32 v42, v100, v101
  v_exp_f32 v105, v105
  v_mfma_f32_32x32x16_bf16 v[240:255], v[76:79], v[44:47], v[240:255]
  ds_read_b64_tr_b16 v[68:69], v6 offset:320
  ds_read_b64_tr_b16 v[70:71], v6 offset:3392
  v_fma_f32 v109, v109, s41, -v7
  v_add_f32 v8, v8, v102
  v_exp_f32 v106, v106
  v_fma_f32 v110, v110, s41, -v7
  v_add_f32 v8, v8, v103
  v_cvt_pk_bf16_f32 v43, v102, v103
  s_cbranch_vccnz RARE2_T0z
RET2_T0z:
  s_branch FIN_0
L_ONE:
  s_cbranch_execz RETH_RX
  ds_read_b64_tr_b16 v[48:49], v5 offset:0
  ds_read_b64_tr_b16 v[50:51], v5 offset:3072
  ds_read_b64_tr_b16 v[52:53], v6 offset:64
  ds_read_b64_tr_b16 v[54:55], v6 offset:3136
  ds_read_b64_tr_b16 v[56:57], v5 offset:128
  ds_read_b64_tr_b16 v[58:59], v5 offset:3200
  ds_read_b64_tr_b16 v[60:61], v6 offset:192
  ds_read_b64_tr_b16 v[62:63], v6 offset:3264
  ds_read_b64_tr_b16 v[64:65], v5 offset:256
  ds_read_b64_tr_b16 v[66:67], v5 offset:3328
  ds_read_b64_tr_b16 v[68:69], v6 offset:320
  ds_read_b64_tr_b16 v[70:71], v6 offset:3392
  v_cndmask_b32 v80, v80, v13, s[56:57]
  v_cndmask_b32 v81, v81, v13, s[58:59]
  v_cndmask_b32 v82, v82, v13, s[60:61]
  v_cndmask_b32 v83, v83, v13, s[62:63]
  v_cndmask_b32 v84, v84, v13, s[64:65]
  v_cndmask_b32 v85, v85, v13, s[66:67]
  v_cndmask_b32 v86, v86, v13, s[68:69]
  v_cndmask_b32 v87, v87, v13, s[70:71]
  v_cndmask_b32 v88, v88, v13, s[72:73]
  v_cndmask_b32 v89, v89, v13, s[74:75]
  v_cndmask_b32 v90, v90, v13, s[76:77]
  v_cndmask_b32 v91, v91, v13, s[78:79]
  v_cndmask_b32 v92, v92, v13, s[80:81]
  v_cndmask_b32 v93, v93, v13, s[82:83]
  v_cndmask_b32 v94, v94, v13, s[84:85]
  v_cndmask_b32 v95, v95, v13, s[86:87]
  v_max3_f32 v10, v80, v81, v82
  v_max3_f32 v11, v83, v84, v85
  v_max3_f32 v10, v10, v86, v87
  v_max3_f32 v11, v11, v88, v89
  v_max3_f32 v10, v10, v90, v91
  v_max3_f32 v11, v11, v92, v93
  v_max3_f32 v10, v10, v94, v95
  v_max_f32 v10, v10, v11
  v_mov_b32 v12, v10
  s_nop 1
  v_permlane32_swap_b32 v10, v12
  v_max_f32 v10, v10, v12
  v_mul_f32 v7, s41, v10
  v_fma_f32 v80, v80, s41, -v7
  v_fma_f32 v81, v81, s41, -v7
  v_fma_f32 v82, v82, s41, -v7
  v_fma_f32 v83, v83, s41, -v7
  v_exp_f32 v80, v80
  v_fma_f32 v84, v84, s41, -v7
  v_exp_f32 v81, v81
  v_fma_f32 v85, v85, s41, -v7
  v_exp_f32 v82, v82
  v_fma_f32 v86, v86, s41, -v7
  v_exp_f32 v83, v83
  v_fma_f32 v87, v87, s41, -v7
  v_add_f32 v8, v8, v80
  v_exp_f32 v84, v84
  v_fma_f32 v88, v88, s41, -v7
  v_add_f32 v8, v8, v81
  v_cvt_pk_bf16_f32 v40, v80, v81
  v_exp_f32 v85, v85
  v_fma_f32 v89, v89, s41, -v7
  v_add_f32 v8, v8, v82
  v_exp_f32 v86, v86
  v_fma_f32 v90, v90, s41, -v7
  v_add_f32 v8, v8, v83
  v_cvt_pk_bf16_f32 v41, v82, v83
  v_exp_f32 v87, v87
  v_fma_f32 v91, v91, s41, -v7
  v_add_f32 v8, v8, v84
  v_exp_f32 v88, v88
  v_fma_f32 v92, v92, s41, -v7
  v_add_f32 v8, v8, v85
  v_cvt_pk_bf16_f32 v42, v84, v85
  v_exp_f32 v89, v89
  v_fma_f32 v93, v93, s41, -v7
  v_add_f32 v8, v8, v86
  v_exp_f32 v90, v90
  v_fma_f32 v94, v94, s41, -v7
  v_add_f32 v8, v8, v87
  v_cvt_pk_bf16_f32 v43, v86, v87
FIN_1z:
  s_nop 1
  s_waitcnt lgkmcnt(6)
  v_mfma_f32_32x32x16_bf16 v[160:175], v[48:51], v[40:43], 0
  ds_read_b64_tr_b16 v[72:73], v5 offset:6144
  ds_read_b64_tr_b16 v[74:75], v5 offset:9216
  v_exp_f32 v91, v91
  v_fma_f32 v95, v95, s41, -v7
  v_add_f32 v8, v8, v88
  v_mfma_f32_32x32x16_bf16 v[176:191], v[52:55], v[40:43], 0
  ds_read_b64_tr_b16 v[76:77], v6 offset:6208
  ds_read_b64_tr_b16 v[78:79], v6 offset:9280
  v_exp_f32 v92, v92
  v_add_f32 v8, v8, v89
  v_cvt_pk_bf16_f32 v44, v88, v89
  v_exp_f32 v93, v93
  v_mfma_f32_32x32x16_bf16 v[192:207], v[56:59], v[40:43], 0
  ds_read_b64_tr_b16 v[48:49], v5 offset:6272
  ds_read_b64_tr_b16 v[50:51], v5 offset:9344
  v_add_f32 v8, v8, v90
  v_exp_f32 v94, v94
  s_waitcnt lgkmcnt(6)
  v_mfma_f32_32x32x16_bf16 v[208:223], v[60:63], v[40:43], 0
  ds_read_b64_tr_b16 v[52:53], v6 offset:6336
  ds_read_b64_tr_b16 v[54:55], v6 offset:9408
  v_add_f32 v8, v8, v91
  v_cvt_pk_bf16_f32 v45, v90, v91
  v_exp_f32 v95, v95
  v_add_f32 v8, v8, v92
  v_mfma_f32_32x32x16_bf16 v[224:239], v[64:67], v[40:43], 0
  ds_read_b64_tr_b16 v[56:57], v5 offset:6400
  ds_read_b64_tr_b16 v[58:59], v5 offset:9472
  v_add_f32 v8, v8, v93
  v_cvt_pk_bf16_f32 v46, v92, v93
  v_add_f32 v8, v8, v94
  v_add_f32 v8, v8, v95
  v_cvt_pk_bf16_f32 v47, v94, v95
  v_mfma_f32_32x32x16_bf16 v[240:255], v[68:71], v[40:43], 0
  ds_read_b64_tr_b16 v[60:61], v6 offset:6464
  ds_read_b64_tr_b16 v[62:63], v6 offset:9536
  s_mul_i32 s48, s45, 43
  s_lshr_b32 s48, s48, 8
  s_mul_i32 s48, s48, 6
  s_waitcnt lgkmcnt(6)
  v_mfma_f32_32x32x16_bf16 v[160:175], v[72:75], v[44:47], v[160:175]
  v_mov_b32 v12, v8
  s_sub_u32 s51, s45, s48
  s_bfe_u32 s3, s34, 0x10009
  s_add_u32 s50, s51, s52
  s_sub_u32 s48, s50, 6
  s_min_u32 s50, s50, s48
  v_mfma_f32_32x32x16_bf16 v[176:191], v[76:79], v[44:47], v[176:191]
  v_permlane32_swap_b32 v8, v12
  v_add_f32 v8, v8, v12
  s_mul_i32 s50, s50, 24576
  s_add_u32 s50, s50, s42
  v_add_u32 v96, s50, v21
  v_add_u32 v104, s50, v23
  v_mfma_f32_32x32x16_bf16 v[192:207], v[48:51], v[44:47], v[192:207]
  v_rcp_f32 v9, v8
  v_xor_b32 v97, 16, v96
  v_xor_b32 v98, 32, v96
  v_xor_b32 v99, 48, v96
  s_waitcnt lgkmcnt(0)
  v_mfma_f32_32x32x16_bf16 v[208:223], v[52:55], v[44:47], v[208:223]
  v_xor_b32 v100, 64, v96
  v_xor_b32 v101, 80, v96
  v_xor_b32 v102, 96, v96
  v_xor_b32 v103, 112, v96
  v_mfma_f32_32x32x16_bf16 v[224:239], v[56:59], v[44:47], v[224:239]
  v_mfma_f32_32x32x16_bf16 v[240:255], v[60:63], v[44:47], v[240:255]
  s_branch L_EPI
.p2align 12
L_MERGE:
  s_cbranch_execz RETH_RX
  v_add_u32 v104, s50, v22
  v_lshrrev_b32 v99, 1, v22
  s_lshl_b32 s48, s32, 9
  s_add_u32 s48, s48, 147456
  v_add_u32 v99, s48, v99
  s_xor_b32 s35, s52, 1
  s_add_u32 s35, s35, s45
  s_add_u32 s36, s45, 2
  s_mul_i32 s48, s35, 43
  s_lshr_b32 s48, s48, 8
  s_mul_i32 s48, s48, 6
  s_sub_u32 s35, s35, s48
  s_mul_i32 s35, s35, 24576
  s_mul_i32 s48, s53, 12288
  s_add_u32 s35, s35, s48
  s_mul_i32 s48, s36, 43
  s_lshr_b32 s48, s48, 8
  s_mul_i32 s48, s48, 6
  s_sub_u32 s36, s36, s48
  s_mul_i32 s36, s36, 24576
  s_mul_i32 s48, s53, 12288
  s_add_u32 s36, s36, s48
  v_mov_b32 v30, v7
  v_mov_b32 v31, v8
  ds_write_b64 v99, v[30:31]
  v_xor_b32 v98, 1024, v99
  v_add_u32 v97, s35, v22
  v_add_u32 v96, s36, v21
  v_add_u32 v105, s36, v23
  s_cmp_eq_u32 s52, 0
  s_cbranch_scc0 L_MERGE1
  ds_write_b128 v104, v[208:211] offset:0
  ds_write_b128 v104, v[212:215] offset:1024
  ds_write_b128 v104, v[216:219] offset:2048
  ds_write_b128 v104, v[220:223] offset:3072
  ds_write_b128 v104, v[224:227] offset:4096
  ds_write_b128 v104, v[228:231] offset:5120
  ds_write_b128 v104, v[232:235] offset:6144
  ds_write_b128 v104, v[236:239] offset:7168
  ds_write_b128 v104, v[240:243] offset:8192
  ds_write_b128 v104, v[244:247] offset:9216
  ds_write_b128 v104, v[248:251] offset:10240
  ds_write_b128 v104, v[252:255] offset:11264
  s_waitcnt lgkmcnt(0)
  s_barrier
  ds_read_b64 v[30:31], v98
  ds_read_b128 v[112:115], v97 offset:0
  ds_read_b128 v[116:119], v97 offset:1024
  ds_read_b128 v[120:123], v97 offset:2048
  ds_read_b128 v[124:127], v97 offset:3072
  ds_read_b128 v[128:131], v97 offset:4096
  ds_read_b128 v[132:135], v97 offset:5120
  ds_read_b128 v[136:139], v97 offset:6144
  ds_read_b128 v[140:143], v97 offset:7168
  ds_read_b128 v[144:147], v97 offset:8192
  ds_read_b128 v[148:151], v97 offset:9216
  ds_read_b128 v[152:155], v97 offset:10240
  ds_read_b128 v[156:159], v97 offset:11264
  s_waitcnt lgkmcnt(12)
  v_max_f32 v10, v7, v30
  v_sub_f32 v11, v7, v10
  v_sub_f32 v12, v30, v10
  v_exp_f32 v11, v11
  v_exp_f32 v12, v12
  s_nop 0
  v_mul_f32 v10, v8, v11
  v_fma_f32 v10, v31, v12, v10
  v_rcp_f32 v10, v10
  s_nop 0
  v_mul_f32 v30, v11, v10
  v_mul_f32 v31, v12, v10
  v_xor_b32 v97, 16, v96
  v_xor_b32 v98, 32, v96
  v_xor_b32 v99, 48, v96
  v_xor_b32 v100, 64, v96
  v_xor_b32 v101, 80, v96
  v_xor_b32 v102, 96, v96
  v_xor_b32 v103, 112, v96
  v_pk_mul_f32 v[160:161], v[160:161], v[30:31] op_sel:[0,0] op_sel_hi:[1,0]
  v_pk_mul_f32 v[162:163], v[162:163], v[30:31] op_sel:[0,0] op_sel_hi:[1,0]
  s_waitcnt lgkmcnt(11)
  v_pk_fma_f32 v[160:161], v[112:113], v[30:31], v[160:161] op_sel:[0,1,0] op_sel_hi:[1,1,1]
  v_pk_fma_f32 v[162:163], v[114:115], v[30:31], v[162:163] op_sel:[0,1,0] op_sel_hi:[1,1,1]
  v_cvt_pk_bf16_f32 v160, v160, v161
  v_cvt_pk_bf16_f32 v161, v162, v163
  ds_write_b64 v96, v[160:161] offset:0
  v_pk_mul_f32 v[164:165], v[164:165], v[30:31] op_sel:[0,0] op_sel_hi:[1,0]
  v_pk_mul_f32 v[166:167], v[166:167], v[30:31] op_sel:[0,0] op_sel_hi:[1,0]
  s_waitcnt lgkmcnt(11)
  v_pk_fma_f32 v[164:165], v[116:117], v[30:31], v[164:165] op_sel:[0,1,0] op_sel_hi:[1,1,1]
  v_pk_fma_f32 v[166:167], v[118:119], v[30:31], v[166:167] op_sel:[0,1,0] op_sel_hi:[1,1,1]
  v_cvt_pk_bf16_f32 v164, v164, v165
  v_cvt_pk_bf16_f32 v165, v166, v167
  ds_write_b64 v97, v[164:165] offset:0
  v_pk_mul_f32 v[168:169], v[168:169], v[30:31] op_sel:[0,0] op_sel_hi:[1,0]
  v_pk_mul_f32 v[170:171], v[170:171], v[30:31] op_sel:[0,0] op_sel_hi:[1,0]
  s_waitcnt lgkmcnt(11)
  v_pk_fma_f32 v[168:169], v[120:121], v[30:31], v[168:169] op_sel:[0,1,0] op_sel_hi:[1,1,1]
  v_pk_fma_f32 v[170:171], v[122:123], v[30:31], v[170:171] op_sel:[0,1,0] op_sel_hi:[1,1,1]
  v_cvt_pk_bf16_f32 v168, v168, v169
  v_cvt_pk_bf16_f32 v169, v170, v171
  ds_write_b64 v98, v[168:169] offset:0
  v_pk_mul_f32 v[172:173], v[172:173], v[30:31] op_sel:[0,0] op_sel_hi:[1,0]
  v_pk_mul_f32 v[174:175], v[174:175], v[30:31] op_sel:[0,0] op_sel_hi:[1,0]
  s_waitcnt lgkmcnt(11)
  v_pk_fma_f32 v[172:173], v[124:125], v[30:31], v[172:173] op_sel:[0,1,0] op_sel_hi:[1,1,1]
  v_pk_fma_f32 v[174:175], v[126:127], v[30:31], v[174:175] op_sel:[0,1,0] op_sel_hi:[1,1,1]
  v_cvt_pk_bf16_f32 v172, v172, v173
  v_cvt_pk_bf16_f32 v173, v174, v175
  ds_write_b64 v99, v[172:173] offset:0
  v_pk_mul_f32 v[176:177], v[176:177], v[30:31] op_sel:[0,0] op_sel_hi:[1,0]
  v_pk_mul_f32 v[178:179], v[178:179], v[30:31] op_sel:[0,0] op_sel_hi:[1,0]
  s_waitcnt lgkmcnt(11)
  v_pk_fma_f32 v[176:177], v[128:129], v[30:31], v[176:177] op_sel:[0,1,0] op_sel_hi:[1,1,1]
  v_pk_fma_f32 v[178:179], v[130:131], v[30:31], v[178:179] op_sel:[0,1,0] op_sel_hi:[1,1,1]
  v_cvt_pk_bf16_f32 v176, v176, v177
  v_cvt_pk_bf16_f32 v177, v178, v179
  ds_write_b64 v100, v[176:177] offset:0
  v_pk_mul_f32 v[180:181], v[180:181], v[30:31] op_sel:[0,0] op_sel_hi:[1,0]
  v_pk_mul_f32 v[182:183], v[182:183], v[30:31] op_sel:[0,0] op_sel_hi:[1,0]
  s_waitcnt lgkmcnt(11)
  v_pk_fma_f32 v[180:181], v[132:133], v[30:31], v[180:181] op_sel:[0,1,0] op_sel_hi:[1,1,1]
  v_pk_fma_f32 v[182:183], v[134:135], v[30:31], v[182:183] op_sel:[0,1,0] op_sel_hi:[1,1,1]
  v_cvt_pk_bf16_f32 v180, v180, v181
  v_cvt_pk_bf16_f32 v181, v182, v183
  ds_write_b64 v101, v[180:181] offset:0
  v_pk_mul_f32 v[184:185], v[184:185], v[30:31] op_sel:[0,0] op_sel_hi:[1,0]
  v_pk_mul_f32 v[186:187], v[186:187], v[30:31] op_sel:[0,0] op_sel_hi:[1,0]
  s_waitcnt lgkmcnt(11)
  v_pk_fma_f32 v[184:185], v[136:137], v[30:31], v[184:185] op_sel:[0,1,0] op_sel_hi:[1,1,1]
  v_pk_fma_f32 v[186:187], v[138:139], v[30:31], v[186:187] op_sel:[0,1,0] op_sel_hi:[1,1,1]
  v_cvt_pk_bf16_f32 v184, v184, v185
  v_cvt_pk_bf16_f32 v185, v186, v187
  ds_write_b64 v102, v[184:185] offset:0
  v_pk_mul_f32 v[188:189], v[188:189], v[30:31] op_sel:[0,0] op_sel_hi:[1,0]
  v_pk_mul_f32 v[190:191], v[190:191], v[30:31] op_sel:[0,0] op_sel_hi:[1,0]
  s_waitcnt lgkmcnt(11)
  v_pk_fma_f32 v[188:189], v[140:141], v[30:31], v[188:189] op_sel:[0,1,0] op_sel_hi:[1,1,1]
  v_pk_fma_f32 v[190:191], v[142:143], v[30:31], v[190:191] op_sel:[0,1,0] op_sel_hi:[1,1,1]
  v_cvt_pk_bf16_f32 v188, v188, v189
  v_cvt_pk_bf16_f32 v189, v190, v191
  ds_write_b64 v103, v[188:189] offset:0
  v_pk_mul_f32 v[192:193], v[192:193], v[30:31] op_sel:[0,0] op_sel_hi:[1,0]
  v_pk_mul_f32 v[194:195], v[194:195], v[30:31] op_sel:[0,0] op_sel_hi:[1,0]
  s_waitcnt lgkmcnt(11)
  v_pk_fma_f32 v[192:193], v[144:145], v[30:31], v[192:193] op_sel:[0,1,0] op_sel_hi:[1,1,1]
  v_pk_fma_f32 v[194:195], v[146:147], v[30:31], v[194:195] op_sel:[0,1,0] op_sel_hi:[1,1,1]
  v_cvt_pk_bf16_f32 v192, v192, v193
  v_cvt_pk_bf16_f32 v193, v194, v195
  ds_write_b64 v96, v[192:193] offset:128
  v_pk_mul_f32 v[196:197], v[196:197], v[30:31] op_sel:[0,0] op_sel_hi:[1,0]
  v_pk_mul_f32 v[198:199], v[198:199], v[30:31] op_sel:[0,0] op_sel_hi:[1,0]
  s_waitcnt lgkmcnt(11)
  v_pk_fma_f32 v[196:197], v[148:149], v[30:31], v[196:197] op_sel:[0,1,0] op_sel_hi:[1,1,1]
  v_pk_fma_f32 v[198:199], v[150:151], v[30:31], v[198:199] op_sel:[0,1,0] op_sel_hi:[1,1,1]
  v_cvt_pk_bf16_f32 v196, v196, v197
  v_cvt_pk_bf16_f32 v197, v198, v199
  ds_write_b64 v97, v[196:197] offset:128
  v_pk_mul_f32 v[200:201], v[200:201], v[30:31] op_sel:[0,0] op_sel_hi:[1,0]
  v_pk_mul_f32 v[202:203], v[202:203], v[30:31] op_sel:[0,0] op_sel_hi:[1,0]
  s_waitcnt lgkmcnt(11)
  v_pk_fma_f32 v[200:201], v[152:153], v[30:31], v[200:201] op_sel:[0,1,0] op_sel_hi:[1,1,1]
  v_pk_fma_f32 v[202:203], v[154:155], v[30:31], v[202:203] op_sel:[0,1,0] op_sel_hi:[1,1,1]
  v_cvt_pk_bf16_f32 v200, v200, v201
  v_cvt_pk_bf16_f32 v201, v202, v203
  ds_write_b64 v98, v[200:201] offset:128
  v_pk_mul_f32 v[204:205], v[204:205], v[30:31] op_sel:[0,0] op_sel_hi:[1,0]
  v_pk_mul_f32 v[206:207], v[206:207], v[30:31] op_sel:[0,0] op_sel_hi:[1,0]
  s_waitcnt lgkmcnt(11)
  v_pk_fma_f32 v[204:205], v[156:157], v[30:31], v[204:205] op_sel:[0,1,0] op_sel_hi:[1,1,1]
  v_pk_fma_f32 v[206:207], v[158:159], v[30:31], v[206:207] op_sel:[0,1,0] op_sel_hi:[1,1,1]
  v_cvt_pk_bf16_f32 v204, v204, v205
  v_cvt_pk_bf16_f32 v205, v206, v207
  ds_write_b64 v99, v[204:205] offset:128
  s_waitcnt lgkmcnt(0)
  s_barrier
  ds_read_b128 v[48:51], v105 offset:0
  ds_read_b128 v[64:67], v105 offset:128
  ds_read_b128 v[80:83], v105 offset:256
  ds_read_b128 v[52:55], v105 offset:3072
  ds_read_b128 v[68:71], v105 offset:3200
  ds_read_b128 v[84:87], v105 offset:3328
  s_add_u32 s44, s44, 0
  s_add_u32 s35, s44, 49152
  s_waitcnt lgkmcnt(5)
  buffer_store_dwordx4 v[48:51], v24, s[28:31], s44 offen offset:0 sc0 sc1 nt
  s_waitcnt lgkmcnt(4)
  buffer_store_dwordx4 v[64:67], v24, s[28:31], s44 offen offset:128 sc0 sc1 nt
  s_waitcnt lgkmcnt(3)
  buffer_store_dwordx4 v[80:83], v24, s[28:31], s44 offen offset:256 sc0 sc1 nt
  s_waitcnt lgkmcnt(2)
  buffer_store_dwordx4 v[52:55], v25, s[28:31], s35 offen offset:0 sc0 sc1 nt
  s_waitcnt lgkmcnt(1)
  buffer_store_dwordx4 v[68:71], v25, s[28:31], s35 offen offset:128 sc0 sc1 nt
  s_waitcnt lgkmcnt(0)
  buffer_store_dwordx4 v[84:87], v25, s[28:31], s35 offen offset:256 sc0 sc1 nt
  s_branch L_DONE
L_MERGE1:
  s_cbranch_execz RETH_RX
  ds_write_b128 v104, v[160:163] offset:0
  ds_write_b128 v104, v[164:167] offset:1024
  ds_write_b128 v104, v[168:171] offset:2048
  ds_write_b128 v104, v[172:175] offset:3072
  ds_write_b128 v104, v[176:179] offset:4096
  ds_write_b128 v104, v[180:183] offset:5120
  ds_write_b128 v104, v[184:187] offset:6144
  ds_write_b128 v104, v[188:191] offset:7168
  ds_write_b128 v104, v[192:195] offset:8192
  ds_write_b128 v104, v[196:199] offset:9216
  ds_write_b128 v104, v[200:203] offset:10240
  ds_write_b128 v104, v[204:207] offset:11264
  s_waitcnt lgkmcnt(0)
  s_barrier
  ds_read_b64 v[30:31], v98
  ds_read_b128 v[112:115], v97 offset:0
  ds_read_b128 v[116:119], v97 offset:1024
  ds_read_b128 v[120:123], v97 offset:2048
  ds_read_b128 v[124:127], v97 offset:3072
  ds_read_b128 v[128:131], v97 offset:4096
  ds_read_b128 v[132:135], v97 offset:5120
  ds_read_b128 v[136:139], v97 offset:6144
  ds_read_b128 v[140:143], v97 offset:7168
  ds_read_b128 v[144:147], v97 offset:8192
  ds_read_b128 v[148:151], v97 offset:9216
  ds_read_b128 v[152:155], v97 offset:10240
  ds_read_b128 v[156:159], v97 offset:11264
  s_waitcnt lgkmcnt(12)
  v_max_f32 v10, v7, v30
  v_sub_f32 v11, v7, v10
  v_sub_f32 v12, v30, v10
  v_exp_f32 v11, v11
  v_exp_f32 v12, v12
  s_nop 0
  v_mul_f32 v10, v8, v11
  v_fma_f32 v10, v31, v12, v10
  v_rcp_f32 v10, v10
  s_nop 0
  v_mul_f32 v30, v11, v10
  v_mul_f32 v31, v12, v10
  v_xor_b32 v97, 16, v96
  v_xor_b32 v98, 32, v96
  v_xor_b32 v99, 48, v96
  v_xor_b32 v100, 64, v96
  v_xor_b32 v101, 80, v96
  v_xor_b32 v102, 96, v96
  v_xor_b32 v103, 112, v96
  v_pk_mul_f32 v[208:209], v[208:209], v[30:31] op_sel:[0,0] op_sel_hi:[1,0]
  v_pk_mul_f32 v[210:211], v[210:211], v[30:31] op_sel:[0,0] op_sel_hi:[1,0]
  s_waitcnt lgkmcnt(11)
  v_pk_fma_f32 v[208:209], v[112:113], v[30:31], v[208:209] op_sel:[0,1,0] op_sel_hi:[1,1,1]
  v_pk_fma_f32 v[210:211], v[114:115], v[30:31], v[210:211] op_sel:[0,1,0] op_sel_hi:[1,1,1]
  v_cvt_pk_bf16_f32 v208, v208, v209
  v_cvt_pk_bf16_f32 v209, v210, v211
  ds_write_b64 v100, v[208:209] offset:128
  v_pk_mul_f32 v[212:213], v[212:213], v[30:31] op_sel:[0,0] op_sel_hi:[1,0]
  v_pk_mul_f32 v[214:215], v[214:215], v[30:31] op_sel:[0,0] op_sel_hi:[1,0]
  s_waitcnt lgkmcnt(11)
  v_pk_fma_f32 v[212:213], v[116:117], v[30:31], v[212:213] op_sel:[0,1,0] op_sel_hi:[1,1,1]
  v_pk_fma_f32 v[214:215], v[118:119], v[30:31], v[214:215] op_sel:[0,1,0] op_sel_hi:[1,1,1]
  v_cvt_pk_bf16_f32 v212, v212, v213
  v_cvt_pk_bf16_f32 v213, v214, v215
  ds_write_b64 v101, v[212:213] offset:128
  v_pk_mul_f32 v[216:217], v[216:217], v[30:31] op_sel:[0,0] op_sel_hi:[1,0]
  v_pk_mul_f32 v[218:219], v[218:219], v[30:31] op_sel:[0,0] op_sel_hi:[1,0]
  s_waitcnt lgkmcnt(11)
  v_pk_fma_f32 v[216:217], v[120:121], v[30:31], v[216:217] op_sel:[0,1,0] op_sel_hi:[1,1,1]
  v_pk_fma_f32 v[218:219], v[122:123], v[30:31], v[218:219] op_sel:[0,1,0] op_sel_hi:[1,1,1]
  v_cvt_pk_bf16_f32 v216, v216, v217
  v_cvt_pk_bf16_f32 v217, v218, v219
  ds_write_b64 v102, v[216:217] offset:128
  v_pk_mul_f32 v[220:221], v[220:221], v[30:31] op_sel:[0,0] op_sel_hi:[1,0]
  v_pk_mul_f32 v[222:223], v[222:223], v[30:31] op_sel:[0,0] op_sel_hi:[1,0]
  s_waitcnt lgkmcnt(11)
  v_pk_fma_f32 v[220:221], v[124:125], v[30:31], v[220:221] op_sel:[0,1,0] op_sel_hi:[1,1,1]
  v_pk_fma_f32 v[222:223], v[126:127], v[30:31], v[222:223] op_sel:[0,1,0] op_sel_hi:[1,1,1]
  v_cvt_pk_bf16_f32 v220, v220, v221
  v_cvt_pk_bf16_f32 v221, v222, v223
  ds_write_b64 v103, v[220:221] offset:128
  v_pk_mul_f32 v[224:225], v[224:225], v[30:31] op_sel:[0,0] op_sel_hi:[1,0]
  v_pk_mul_f32 v[226:227], v[226:227], v[30:31] op_sel:[0,0] op_sel_hi:[1,0]
  s_waitcnt lgkmcnt(11)
  v_pk_fma_f32 v[224:225], v[128:129], v[30:31], v[224:225] op_sel:[0,1,0] op_sel_hi:[1,1,1]
  v_pk_fma_f32 v[226:227], v[130:131], v[30:31], v[226:227] op_sel:[0,1,0] op_sel_hi:[1,1,1]
  v_cvt_pk_bf16_f32 v224, v224, v225
  v_cvt_pk_bf16_f32 v225, v226, v227
  ds_write_b64 v96, v[224:225] offset:256
  v_pk_mul_f32 v[228:229], v[228:229], v[30:31] op_sel:[0,0] op_sel_hi:[1,0]
  v_pk_mul_f32 v[230:231], v[230:231], v[30:31] op_sel:[0,0] op_sel_hi:[1,0]
  s_waitcnt lgkmcnt(11)
  v_pk_fma_f32 v[228:229], v[132:133], v[30:31], v[228:229] op_sel:[0,1,0] op_sel_hi:[1,1,1]
  v_pk_fma_f32 v[230:231], v[134:135], v[30:31], v[230:231] op_sel:[0,1,0] op_sel_hi:[1,1,1]
  v_cvt_pk_bf16_f32 v228, v228, v229
  v_cvt_pk_bf16_f32 v229, v230, v231
  ds_write_b64 v97, v[228:229] offset:256
  v_pk_mul_f32 v[232:233], v[232:233], v[30:31] op_sel:[0,0] op_sel_hi:[1,0]
  v_pk_mul_f32 v[234:235], v[234:235], v[30:31] op_sel:[0,0] op_sel_hi:[1,0]
  s_waitcnt lgkmcnt(11)
  v_pk_fma_f32 v[232:233], v[136:137], v[30:31], v[232:233] op_sel:[0,1,0] op_sel_hi:[1,1,1]
  v_pk_fma_f32 v[234:235], v[138:139], v[30:31], v[234:235] op_sel:[0,1,0] op_sel_hi:[1,1,1]
  v_cvt_pk_bf16_f32 v232, v232, v233
  v_cvt_pk_bf16_f32 v233, v234, v235
  ds_write_b64 v98, v[232:233] offset:256
  v_pk_mul_f32 v[236:237], v[236:237], v[30:31] op_sel:[0,0] op_sel_hi:[1,0]
  v_pk_mul_f32 v[238:239], v[238:239], v[30:31] op_sel:[0,0] op_sel_hi:[1,0]
  s_waitcnt lgkmcnt(11)
  v_pk_fma_f32 v[236:237], v[140:141], v[30:31], v[236:237] op_sel:[0,1,0] op_sel_hi:[1,1,1]
  v_pk_fma_f32 v[238:239], v[142:143], v[30:31], v[238:239] op_sel:[0,1,0] op_sel_hi:[1,1,1]
  v_cvt_pk_bf16_f32 v236, v236, v237
  v_cvt_pk_bf16_f32 v237, v238, v239
  ds_write_b64 v99, v[236:237] offset:256
  v_pk_mul_f32 v[240:241], v[240:241], v[30:31] op_sel:[0,0] op_sel_hi:[1,0]
  v_pk_mul_f32 v[242:243], v[242:243], v[30:31] op_sel:[0,0] op_sel_hi:[1,0]
  s_waitcnt lgkmcnt(11)
  v_pk_fma_f32 v[240:241], v[144:145], v[30:31], v[240:241] op_sel:[0,1,0] op_sel_hi:[1,1,1]
  v_pk_fma_f32 v[242:243], v[146:147], v[30:31], v[242:243] op_sel:[0,1,0] op_sel_hi:[1,1,1]
  v_cvt_pk_bf16_f32 v240, v240, v241
  v_cvt_pk_bf16_f32 v241, v242, v243
  ds_write_b64 v100, v[240:241] offset:256
  v_pk_mul_f32 v[244:245], v[244:245], v[30:31] op_sel:[0,0] op_sel_hi:[1,0]
  v_pk_mul_f32 v[246:247], v[246:247], v[30:31] op_sel:[0,0] op_sel_hi:[1,0]
  s_waitcnt lgkmcnt(11)
  v_pk_fma_f32 v[244:245], v[148:149], v[30:31], v[244:245] op_sel:[0,1,0] op_sel_hi:[1,1,1]
  v_pk_fma_f32 v[246:247], v[150:151], v[30:31], v[246:247] op_sel:[0,1,0] op_sel_hi:[1,1,1]
  v_cvt_pk_bf16_f32 v244, v244, v245
  v_cvt_pk_bf16_f32 v245, v246, v247
  ds_write_b64 v101, v[244:245] offset:256
  v_pk_mul_f32 v[248:249], v[248:249], v[30:31] op_sel:[0,0] op_sel_hi:[1,0]
  v_pk_mul_f32 v[250:251], v[250:251], v[30:31] op_sel:[0,0] op_sel_hi:[1,0]
  s_waitcnt lgkmcnt(11)
  v_pk_fma_f32 v[248:249], v[152:153], v[30:31], v[248:249] op_sel:[0,1,0] op_sel_hi:[1,1,1]
  v_pk_fma_f32 v[250:251], v[154:155], v[30:31], v[250:251] op_sel:[0,1,0] op_sel_hi:[1,1,1]
  v_cvt_pk_bf16_f32 v248, v248, v249
  v_cvt_pk_bf16_f32 v249, v250, v251
  ds_write_b64 v102, v[248:249] offset:256
  v_pk_mul_f32 v[252:253], v[252:253], v[30:31] op_sel:[0,0] op_sel_hi:[1,0]
  v_pk_mul_f32 v[254:255], v[254:255], v[30:31] op_sel:[0,0] op_sel_hi:[1,0]
  s_waitcnt lgkmcnt(11)
  v_pk_fma_f32 v[252:253], v[156:157], v[30:31], v[252:253] op_sel:[0,1,0] op_sel_hi:[1,1,1]
  v_pk_fma_f32 v[254:255], v[158:159], v[30:31], v[254:255] op_sel:[0,1,0] op_sel_hi:[1,1,1]
  v_cvt_pk_bf16_f32 v252, v252, v253
  v_cvt_pk_bf16_f32 v253, v254, v255
  ds_write_b64 v103, v[252:253] offset:256
  s_waitcnt lgkmcnt(0)
  s_barrier
  ds_read_b128 v[48:51], v105 offset:6144
  ds_read_b128 v[64:67], v105 offset:6272
  ds_read_b128 v[80:83], v105 offset:6400
  ds_read_b128 v[52:55], v105 offset:9216
  ds_read_b128 v[68:71], v105 offset:9344
  ds_read_b128 v[84:87], v105 offset:9472
  s_add_u32 s44, s44, s55
  s_add_u32 s35, s44, 49152
  s_waitcnt lgkmcnt(5)
  buffer_store_dwordx4 v[48:51], v24, s[28:31], s44 offen offset:0 sc0 sc1 nt
  s_waitcnt lgkmcnt(4)
  buffer_store_dwordx4 v[64:67], v24, s[28:31], s44 offen offset:128 sc0 sc1 nt
  s_waitcnt lgkmcnt(3)
  buffer_store_dwordx4 v[80:83], v24, s[28:31], s44 offen offset:256 sc0 sc1 nt
  s_waitcnt lgkmcnt(2)
  buffer_store_dwordx4 v[52:55], v25, s[28:31], s35 offen offset:0 sc0 sc1 nt
  s_waitcnt lgkmcnt(1)
  buffer_store_dwordx4 v[68:71], v25, s[28:31], s35 offen offset:128 sc0 sc1 nt
  s_waitcnt lgkmcnt(0)
  buffer_store_dwordx4 v[84:87], v25, s[28:31], s35 offen offset:256 sc0 sc1 nt
  s_branch L_DONE
L_SH3:
  s_cbranch_execz RETH_R1
  s_add_u32 m0, s50, 24576
  s_sub_u32 s67, s55, 196608
  s_sub_u32 s62, s62, 196608
  buffer_load_dwordx4 v20, s[24:27], s67 offen offset:0 nt lds
  buffer_load_dwordx4 v21, s[24:27], s67 offen offset:1024 nt lds
  buffer_load_dwordx4 v22, s[24:27], s67 offen offset:2048 nt lds
  s_add_u32 m0, s50, 36864
  s_add_u32 s51, s67, 384
  buffer_load_dwordx4 v20, s[24:27], s51 offen offset:0 nt lds
  buffer_load_dwordx4 v21, s[24:27], s51 offen offset:1024 nt lds
  buffer_load_dwordx4 v22, s[24:27], s51 offen offset:2048 nt lds
  s_add_u32 m0, s50, 73728
  s_add_u32 s63, s63, 98304
  buffer_load_dwordx4 v23, s[16:19], s63 offen offset:0  lds
  buffer_load_dwordx4 v24, s[16:19], s63 offen offset:1024  lds
  buffer_load_dwordx4 v25, s[16:19], s63 offen offset:2048  lds
  s_add_u32 m0, s50, 86016
  s_add_u32 s64, s64, 98304
  buffer_load_dwordx4 v26, s[20:23], s64 offen offset:0  lds
  buffer_load_dwordx4 v27, s[20:23], s64 offen offset:1024  lds
  buffer_load_dwordx4 v28, s[20:23], s64 offen offset:2048  lds
  s_waitcnt vmcnt(12)
  s_barrier
  s_setprio 1
  s_add_u32 m0, s50, 98304
  s_add_u32 s63, s63, 98304
  buffer_load_dwordx4 v23, s[16:19], s63 offen offset:0  lds
  buffer_load_dwordx4 v24, s[16:19], s63 offen offset:1024  lds
  buffer_load_dwordx4 v25, s[16:19], s63 offen offset:2048  lds
  s_add_u32 m0, s50, 110592
  s_add_u32 s64, s64, 98304
  buffer_load_dwordx4 v26, s[20:23], s64 offen offset:0  lds
  buffer_load_dwordx4 v27, s[20:23], s64 offen offset:1024  lds
  buffer_load_dwordx4 v28, s[20:23], s64 offen offset:2048  lds
  s_waitcnt vmcnt(6)
  s_barrier
  s_add_u32 m0, s50, 122880
  s_mov_b32 s18, s71
  s_mov_b32 s63, s70
  buffer_load_dwordx4 v23, s[16:19], s63 offen offset:0  lds
  buffer_load_dwordx4 v24, s[16:19], s63 offen offset:1024  lds
  buffer_load_dwordx4 v25, s[16:19], s63 offen offset:2048  lds
  s_add_u32 m0, s50, 135168
  s_add_u32 s64, s64, 98304
  buffer_load_dwordx4 v26, s[20:23], s64 offen offset:0  lds
  buffer_load_dwordx4 v27, s[20:23], s64 offen offset:1024  lds
  buffer_load_dwordx4 v28, s[20:23], s64 offen offset:2048  lds
  s_add_u32 m0, s50, 0
  s_mov_b32 s26, s69
  s_mov_b32 s67, s68
  buffer_load_dwordx4 v20, s[24:27], s67 offen offset:0 nt lds
  buffer_load_dwordx4 v21, s[24:27], s67 offen offset:1024 nt lds
  buffer_load_dwordx4 v22, s[24:27], s67 offen offset:2048 nt lds
  s_add_u32 m0, s50, 12288
  s_add_u32 s51, s67, 384
  buffer_load_dwordx4 v20, s[24:27], s51 offen offset:0 nt lds
  buffer_load_dwordx4 v21, s[24:27], s51 offen offset:1024 nt lds
  buffer_load_dwordx4 v22, s[24:27], s51 offen offset:2048 nt lds
  s_waitcnt vmcnt(12)
  s_barrier
  s_add_u32 m0, s50, 24576
  s_add_u32 s67, s67, 196608
  buffer_load_dwordx4 v20, s[24:27], s67 offen offset:0 nt lds
  buffer_load_dwordx4 v21, s[24:27], s67 offen offset:1024 nt lds
  buffer_load_dwordx4 v22, s[24:27], s67 offen offset:2048 nt lds
  s_add_u32 m0, s50, 36864
  s_add_u32 s51, s67, 384
  buffer_load_dwordx4 v20, s[24:27], s51 offen offset:0 nt lds
  buffer_load_dwordx4 v21, s[24:27], s51 offen offset:1024 nt lds
  buffer_load_dwordx4 v22, s[24:27], s51 offen offset:2048 nt lds
  s_add_u32 m0, s50, 49152
  s_add_u32 s63, s63, 98304
  buffer_load_dwordx4 v23, s[16:19], s63 offen offset:0  lds
  buffer_load_dwordx4 v24, s[16:19], s63 offen offset:1024  lds
  buffer_load_dwordx4 v25, s[16:19], s63 offen offset:2048  lds
  s_add_u32 m0, s50, 61440
  s_mov_b32 s22, s71
  s_mov_b32 s64, s70
  buffer_load_dwordx4 v26, s[20:23], s64 offen offset:0  lds
  buffer_load_dwordx4 v27, s[20:23], s64 offen offset:1024  lds
  buffer_load_dwordx4 v28, s[20:23], s64 offen offset:2048  lds
  s_waitcnt vmcnt(6)
  s_barrier
  s_waitcnt vmcnt(0)
  s_barrier
  v_add_u32 v32, 0, v29
  v_add_u32 v33, 24576, v29
  ds_read_b128 v[64:67], v32 offset:0
  ds_read_b128 v[80:83], v32 offset:128
  ds_read_b128 v[96:99], v32 offset:256
  ds_read_b128 v[68:71], v32 offset:12288
  ds_read_b128 v[84:87], v32 offset:12416
  ds_read_b128 v[100:103], v32 offset:12544
  ds_read_b128 v[72:75], v33 offset:0
  ds_read_b128 v[88:91], v33 offset:128
  ds_read_b128 v[104:107], v33 offset:256
  ds_read_b128 v[76:79], v33 offset:12288
  ds_read_b128 v[92:95], v33 offset:12416
  ds_read_b128 v[108:111], v33 offset:12544
  s_waitcnt lgkmcnt(0)
  s_add_u32 m0, s50, 73728
  s_add_u32 s63, s63, 98304
  buffer_load_dwordx4 v23, s[16:19], s63 offen offset:0  lds
  buffer_load_dwordx4 v24, s[16:19], s63 offen offset:1024  lds
  buffer_load_dwordx4 v25, s[16:19], s63 offen offset:2048  lds
  s_add_u32 m0, s50, 86016
  s_add_u32 s64, s64, 98304
  buffer_load_dwordx4 v26, s[20:23], s64 offen offset:0  lds
  buffer_load_dwordx4 v27, s[20:23], s64 offen offset:1024  lds
  buffer_load_dwordx4 v28, s[20:23], s64 offen offset:2048  lds
  s_add_u32 m0, s50, 98304
  s_add_u32 s63, s63, 98304
  buffer_load_dwordx4 v23, s[16:19], s63 offen offset:0  lds
  buffer_load_dwordx4 v24, s[16:19], s63 offen offset:1024  lds
  buffer_load_dwordx4 v25, s[16:19], s63 offen offset:2048  lds
  s_add_u32 m0, s50, 110592
  s_add_u32 s64, s64, 98304
  buffer_load_dwordx4 v26, s[20:23], s64 offen offset:0  lds
  buffer_load_dwordx4 v27, s[20:23], s64 offen offset:1024  lds
  buffer_load_dwordx4 v28, s[20:23], s64 offen offset:2048  lds
  s_waitcnt vmcnt(6)
  s_barrier
  s_add_u32 m0, s50, 122880
  s_add_u32 s63, s63, 98304
  buffer_load_dwordx4 v23, s[16:19], s63 offen offset:0  lds
  buffer_load_dwordx4 v24, s[16:19], s63 offen offset:1024  lds
  buffer_load_dwordx4 v25, s[16:19], s63 offen offset:2048  lds
  s_add_u32 m0, s50, 135168
  s_add_u32 s64, s64, 98304
  buffer_load_dwordx4 v26, s[20:23], s64 offen offset:0  lds
  buffer_load_dwordx4 v27, s[20:23], s64 offen offset:1024  lds
  buffer_load_dwordx4 v28, s[20:23], s64 offen offset:2048  lds
  s_waitcnt vmcnt(6)
  s_barrier
  s_add_u32 m0, s50, 0
  s_add_u32 s63, s63, 98304
  buffer_load_dwordx4 v23, s[16:19], s63 offen offset:0  lds
  buffer_load_dwordx4 v24, s[16:19], s63 offen offset:1024  lds
  buffer_load_dwordx4 v25, s[16:19], s63 offen offset:2048  lds
  s_add_u32 m0, s50, 12288
  s_add_u32 s64, s64, 98304
  buffer_load_dwordx4 v26, s[20:23], s64 offen offset:0  lds
  buffer_load_dwordx4 v27, s[20:23], s64 offen offset:1024  lds
  buffer_load_dwordx4 v28, s[20:23], s64 offen offset:2048  lds
  buffer_store_dwordx4 v[64:67], v30, s[28:31], s62 offen offset:0 sc0 sc1 nt
  buffer_store_dwordx4 v[80:83], v30, s[28:31], s62 offen offset:128 sc0 sc1 nt
  buffer_store_dwordx4 v[96:99], v30, s[28:31], s62 offen offset:256 sc0 sc1 nt
  s_waitcnt vmcnt(9)
  s_barrier
  s_add_u32 m0, s50, 36864
  s_add_u32 s64, s64, 98304
  buffer_load_dwordx4 v26, s[20:23], s64 offen offset:0  lds
  buffer_load_dwordx4 v27, s[20:23], s64 offen offset:1024  lds
  buffer_load_dwordx4 v28, s[20:23], s64 offen offset:2048  lds
  buffer_store_dwordx4 v[68:71], v30, s[28:31], s62 offen offset:384 sc0 sc1 nt
  buffer_store_dwordx4 v[84:87], v30, s[28:31], s62 offen offset:512 sc0 sc1 nt
  buffer_store_dwordx4 v[100:103], v30, s[28:31], s62 offen offset:640 sc0 sc1 nt
  s_waitcnt vmcnt(9)
  s_barrier
  s_add_u32 s62, s62, 196608
  buffer_store_dwordx4 v[72:75], v30, s[28:31], s62 offen offset:0 sc0 sc1 nt
  buffer_store_dwordx4 v[88:91], v30, s[28:31], s62 offen offset:128 sc0 sc1 nt
  buffer_store_dwordx4 v[104:107], v30, s[28:31], s62 offen offset:256 sc0 sc1 nt
  s_waitcnt vmcnt(6)
  s_barrier
  buffer_store_dwordx4 v[76:79], v30, s[28:31], s62 offen offset:384 sc0 sc1 nt
  buffer_store_dwordx4 v[92:95], v30, s[28:31], s62 offen offset:512 sc0 sc1 nt
  buffer_store_dwordx4 v[108:111], v30, s[28:31], s62 offen offset:640 sc0 sc1 nt
  s_endpgm
.p2align 12
L_SH2:
  s_cbranch_execz RETH_R1
  s_add_u32 m0, s50, 24576
  s_sub_u32 s67, s55, 196608
  s_sub_u32 s62, s62, 196608
  buffer_load_dwordx4 v20, s[24:27], s67 offen offset:0 nt lds
  buffer_load_dwordx4 v21, s[24:27], s67 offen offset:1024 nt lds
  buffer_load_dwordx4 v22, s[24:27], s67 offen offset:2048 nt lds
  s_add_u32 m0, s50, 36864
  s_add_u32 s51, s67, 384
  buffer_load_dwordx4 v20, s[24:27], s51 offen offset:0 nt lds
  buffer_load_dwordx4 v21, s[24:27], s51 offen offset:1024 nt lds
  buffer_load_dwordx4 v22, s[24:27], s51 offen offset:2048 nt lds
  s_add_u32 m0, s50, 73728
  s_add_u32 s63, s63, 98304
  buffer_load_dwordx4 v23, s[16:19], s63 offen offset:0  lds
  buffer_load_dwordx4 v24, s[16:19], s63 offen offset:1024  lds
  buffer_load_dwordx4 v25, s[16:19], s63 offen offset:2048  lds
  s_add_u32 m0, s50, 86016
  s_add_u32 s64, s64, 98304
  buffer_load_dwordx4 v26, s[20:23], s64 offen offset:0  lds
  buffer_load_dwordx4 v27, s[20:23], s64 offen offset:1024  lds
  buffer_load_dwordx4 v28, s[20:23], s64 offen offset:2048  lds
  s_sub_u32 s49, s3, 5
  s_lshl2_add_u32 m0, s49, s32
  s_mov_b32 s38, 7369728
  s_mov_b32 s39, 0x20000
  s_mov_b32 s36, s6
  s_mov_b32 s37, s7
  s_mov_b32 s74, 0x8013
  s_mov_b32 s75, 0x9860
  s_mov_b32 s76, 0xcb
  s_mov_b32 s77, 0xd8
  s_mov_b32 s78, 0x8215
  s_mov_b32 s79, 0x25cd
  s_mov_b32 s80, 0xd4
  s_mov_b32 s81, 0x7c
  s_mov_b32 s82, 0xb417
  s_mov_b32 s83, 0x271e
  s_mov_b32 s84, 0xd6
  s_mov_b32 s85, 0x7e
  s_movrels_b32 s72, s74
  s_mov_b32 s74, 0xf0200
  s_mov_b32 s75, 0xf0300
  s_mov_b32 s76, 0xf00
  s_mov_b32 s77, 0xf01
  s_mov_b32 s78, 0xf0200
  s_mov_b32 s79, 0xf0300
  s_mov_b32 s80, 0xf00
  s_mov_b32 s81, 0xf01
  s_mov_b32 s82, 0xf0200
  s_mov_b32 s83, 0xf0300
  s_mov_b32 s84, 0xf00
  s_mov_b32 s85, 0xf01
  s_movrels_b32 s73, s74
  s_waitcnt vmcnt(12)
  s_barrier
  s_setprio 1
  s_add_u32 m0, s50, 98304
  s_add_u32 s63, s63, 98304
  buffer_load_dwordx4 v23, s[16:19], s63 offen offset:0  lds
  buffer_load_dwordx4 v24, s[16:19], s63 offen offset:1024  lds
  buffer_load_dwordx4 v25, s[16:19], s63 offen offset:2048  lds
  s_add_u32 m0, s50, 110592
  s_add_u32 s64, s64, 98304
  buffer_load_dwordx4 v26, s[20:23], s64 offen offset:0  lds
  buffer_load_dwordx4 v27, s[20:23], s64 offen offset:1024  lds
  buffer_load_dwordx4 v28, s[20:23], s64 offen offset:2048  lds
  s_and_b32 s49, s73, 15
  s_cmp_lg_u32 s49, 0
  s_cbranch_scc1 L_T2_0
  s_bitcmp1_b32 s72, 0
  s_cselect_b32 s36, s8, s6
  s_cselect_b32 s37, s9, s7
  s_bfe_u32 s40, s73, 0x30004
  s_xor_b32 s40, s40, s33
  s_mul_i32 s40, s40, 384
  s_and_b32 s49, s72, 0xfe
  s_lshl_b32 s49, s49, 5
  s_lshr_b32 s72, s72, 8
  s_lshr_b32 s73, s73, 8
  s_or_b32 s73, s73, 0x0f000000
  v_add_u32 v34, s49, v14
  v_mul_u32_u24 v37, 43691, v34
  v_lshrrev_b32 v37, 17, v37
  v_mul_u32_u24 v37, 2688, v37
  v_lshl_add_u32 v34, v34, 7, v37
  buffer_load_dword v36, v34, s[36:39], s40 offen
L_T2_0:
  s_waitcnt vmcnt(6)
  s_barrier
  s_add_u32 m0, s50, 122880
  s_add_u32 s63, s63, 98304
  buffer_load_dwordx4 v23, s[16:19], s63 offen offset:0  lds
  buffer_load_dwordx4 v24, s[16:19], s63 offen offset:1024  lds
  buffer_load_dwordx4 v25, s[16:19], s63 offen offset:2048  lds
  s_add_u32 m0, s50, 135168
  s_add_u32 s64, s64, 98304
  buffer_load_dwordx4 v26, s[20:23], s64 offen offset:0  lds
  buffer_load_dwordx4 v27, s[20:23], s64 offen offset:1024  lds
  buffer_load_dwordx4 v28, s[20:23], s64 offen offset:2048  lds
  s_add_u32 m0, s50, 0
  s_add_u32 s63, s63, 98304
  buffer_load_dwordx4 v23, s[16:19], s63 offen offset:0  lds
  buffer_load_dwordx4 v24, s[16:19], s63 offen offset:1024  lds
  buffer_load_dwordx4 v25, s[16:19], s63 offen offset:2048  lds
  s_add_u32 m0, s50, 12288
  s_add_u32 s64, s64, 98304
  buffer_load_dwordx4 v26, s[20:23], s64 offen offset:0  lds
  buffer_load_dwordx4 v27, s[20:23], s64 offen offset:1024  lds
  buffer_load_dwordx4 v28, s[20:23], s64 offen offset:2048  lds
  s_and_b32 s49, s73, 15
  s_cmp_lg_u32 s49, 1
  s_cbranch_scc1 L_T2_1
  s_bitcmp1_b32 s72, 0
  s_cselect_b32 s36, s8, s6
  s_cselect_b32 s37, s9, s7
  s_bfe_u32 s40, s73, 0x30004
  s_xor_b32 s40, s40, s33
  s_mul_i32 s40, s40, 384
  s_and_b32 s49, s72, 0xfe
  s_lshl_b32 s49, s49, 5
  s_lshr_b32 s72, s72, 8
  s_lshr_b32 s73, s73, 8
  s_or_b32 s73, s73, 0x0f000000
  v_add_u32 v34, s49, v14
  v_mul_u32_u24 v37, 43691, v34
  v_lshrrev_b32 v37, 17, v37
  v_mul_u32_u24 v37, 2688, v37
  v_lshl_add_u32 v34, v34, 7, v37
  buffer_load_dword v36, v34, s[36:39], s40 offen
L_T2_1:
  s_waitcnt vmcnt(12)
  s_barrier
  s_add_u32 m0, s50, 24576
  s_add_u32 s63, s63, 98304
  buffer_load_dwordx4 v23, s[16:19], s63 offen offset:0  lds
  buffer_load_dwordx4 v24, s[16:19], s63 offen offset:1024  lds
  buffer_load_dwordx4 v25, s[16:19], s63 offen offset:2048  lds
  s_add_u32 m0, s50, 36864
  s_add_u32 s64, s64, 98304
  buffer_load_dwordx4 v26, s[20:23], s64 offen offset:0  lds
  buffer_load_dwordx4 v27, s[20:23], s64 offen offset:1024  lds
  buffer_load_dwordx4 v28, s[20:23], s64 offen offset:2048  lds
  s_and_b32 s49, s73, 15
  s_cmp_lg_u32 s49, 2
  s_cbranch_scc1 L_T2_2
  s_bitcmp1_b32 s72, 0
  s_cselect_b32 s36, s8, s6
  s_cselect_b32 s37, s9, s7
  s_bfe_u32 s40, s73, 0x30004
  s_xor_b32 s40, s40, s33
  s_mul_i32 s40, s40, 384
  s_and_b32 s49, s72, 0xfe
  s_lshl_b32 s49, s49, 5
  s_lshr_b32 s72, s72, 8
  s_lshr_b32 s73, s73, 8
  s_or_b32 s73, s73, 0x0f000000
  v_add_u32 v34, s49, v14
  v_mul_u32_u24 v37, 43691, v34
  v_lshrrev_b32 v37, 17, v37
  v_mul_u32_u24 v37, 2688, v37
  v_lshl_add_u32 v34, v34, 7, v37
  buffer_load_dword v36, v34, s[36:39], s40 offen
L_T2_2:
  s_waitcnt vmcnt(12)
  s_barrier
  s_add_u32 m0, s50, 49152
  s_add_u32 s63, s63, 98304
  buffer_load_dwordx4 v23, s[16:19], s63 offen offset:0  lds
  buffer_load_dwordx4 v24, s[16:19], s63 offen offset:1024  lds
  buffer_load_dwordx4 v25, s[16:19], s63 offen offset:2048  lds
  s_add_u32 m0, s50, 61440
  s_add_u32 s64, s64, 98304
  buffer_load_dwordx4 v26, s[20:23], s64 offen offset:0  lds
  buffer_load_dwordx4 v27, s[20:23], s64 offen offset:1024  lds
  buffer_load_dwordx4 v28, s[20:23], s64 offen offset:2048  lds
  s_and_b32 s49, s73, 15
  s_cmp_lg_u32 s49, 3
  s_cbranch_scc1 L_T2_3
  s_bitcmp1_b32 s72, 0
  s_cselect_b32 s36, s8, s6
  s_cselect_b32 s37, s9, s7
  s_bfe_u32 s40, s73, 0x30004
  s_xor_b32 s40, s40, s33
  s_mul_i32 s40, s40, 384
  s_and_b32 s49, s72, 0xfe
  s_lshl_b32 s49, s49, 5
  s_lshr_b32 s72, s72, 8
  s_lshr_b32 s73, s73, 8
  s_or_b32 s73, s73, 0x0f000000
  v_add_u32 v34, s49, v14
  v_mul_u32_u24 v37, 43691, v34
  v_lshrrev_b32 v37, 17, v37
  v_mul_u32_u24 v37, 2688, v37
  v_lshl_add_u32 v34, v34, 7, v37
  buffer_load_dword v36, v34, s[36:39], s40 offen
L_T2_3:
  s_waitcnt vmcnt(12)
  s_barrier
  s_add_u32 m0, s50, 73728
  s_add_u32 s63, s63, 98304
  buffer_load_dwordx4 v23, s[16:19], s63 offen offset:0  lds
  buffer_load_dwordx4 v24, s[16:19], s63 offen offset:1024  lds
  buffer_load_dwordx4 v25, s[16:19], s63 offen offset:2048  lds
  s_add_u32 m0, s50, 86016
  s_add_u32 s64, s64, 98304
  buffer_load_dwordx4 v26, s[20:23], s64 offen offset:0  lds
  buffer_load_dwordx4 v27, s[20:23], s64 offen offset:1024  lds
  buffer_load_dwordx4 v28, s[20:23], s64 offen offset:2048  lds
  s_waitcnt vmcnt(12)
  s_barrier
  s_add_u32 m0, s50, 98304
  s_add_u32 s63, s63, 98304
  buffer_load_dwordx4 v23, s[16:19], s63 offen offset:0  lds
  buffer_load_dwordx4 v24, s[16:19], s63 offen offset:1024  lds
  buffer_load_dwordx4 v25, s[16:19], s63 offen offset:2048  lds
  s_add_u32 m0, s50, 110592
  s_add_u32 s64, s64, 98304
  buffer_load_dwordx4 v26, s[20:23], s64 offen offset:0  lds
  buffer_load_dwordx4 v27, s[20:23], s64 offen offset:1024  lds
  buffer_load_dwordx4 v28, s[20:23], s64 offen offset:2048  lds
  s_waitcnt vmcnt(12)
  s_barrier
  s_add_u32 m0, s50, 122880
  s_add_u32 s63, s63, 98304
  buffer_load_dwordx4 v23, s[16:19], s63 offen offset:0  lds
  buffer_load_dwordx4 v24, s[16:19], s63 offen offset:1024  lds
  buffer_load_dwordx4 v25, s[16:19], s63 offen offset:2048  lds
  s_add_u32 m0, s50, 135168
  s_add_u32 s64, s64, 98304
  buffer_load_dwordx4 v26, s[20:23], s64 offen offset:0  lds
  buffer_load_dwordx4 v27, s[20:23], s64 offen offset:1024  lds
  buffer_load_dwordx4 v28, s[20:23], s64 offen offset:2048  lds
  s_waitcnt vmcnt(12)
  s_barrier
  s_add_u32 m0, s50, 0
  s_add_u32 s63, s63, 98304
  buffer_load_dwordx4 v23, s[16:19], s63 offen offset:0  lds
  buffer_load_dwordx4 v24, s[16:19], s63 offen offset:1024  lds
  buffer_load_dwordx4 v25, s[16:19], s63 offen offset:2048  lds
  s_add_u32 m0, s50, 12288
  s_add_u32 s64, s64, 98304
  buffer_load_dwordx4 v26, s[20:23], s64 offen offset:0  lds
  buffer_load_dwordx4 v27, s[20:23], s64 offen offset:1024  lds
  buffer_load_dwordx4 v28, s[20:23], s64 offen offset:2048  lds
  s_waitcnt vmcnt(12)
  s_barrier
  s_add_u32 m0, s50, 24576
  s_add_u32 s63, s63, 98304
  buffer_load_dwordx4 v23, s[16:19], s63 offen offset:0  lds
  buffer_load_dwordx4 v24, s[16:19], s63 offen offset:1024  lds
  buffer_load_dwordx4 v25, s[16:19], s63 offen offset:2048  lds
  s_add_u32 m0, s50, 36864
  s_add_u32 s64, s64, 98304
  buffer_load_dwordx4 v26, s[20:23], s64 offen offset:0  lds
  buffer_load_dwordx4 v27, s[20:23], s64 offen offset:1024  lds
  buffer_load_dwordx4 v28, s[20:23], s64 offen offset:2048  lds
  s_waitcnt vmcnt(12)
  s_barrier
  s_add_u32 m0, s50, 61440
  s_add_u32 s64, s64, 98304
  buffer_load_dwordx4 v26, s[20:23], s64 offen offset:0  lds
  buffer_load_dwordx4 v27, s[20:23], s64 offen offset:1024  lds
  buffer_load_dwordx4 v28, s[20:23], s64 offen offset:2048  lds
  s_waitcnt vmcnt(9)
  s_barrier
  s_waitcnt vmcnt(3)
  s_barrier
  s_waitcnt vmcnt(0)
  s_barrier
  s_endpgm
L_SH8:
  s_cbranch_execz RETH_R1
  s_add_u32 m0, s50, 24576
  s_sub_u32 s67, s55, 196608
  s_sub_u32 s62, s62, 196608
  buffer_load_dwordx4 v20, s[24:27], s67 offen offset:0 nt lds
  buffer_load_dwordx4 v21, s[24:27], s67 offen offset:1024 nt lds
  buffer_load_dwordx4 v22, s[24:27], s67 offen offset:2048 nt lds
  s_add_u32 m0, s50, 36864
  s_add_u32 s51, s67, 384
  buffer_load_dwordx4 v20, s[24:27], s51 offen offset:0 nt lds
  buffer_load_dwordx4 v21, s[24:27], s51 offen offset:1024 nt lds
  buffer_load_dwordx4 v22, s[24:27], s51 offen offset:2048 nt lds
  s_add_u32 m0, s50, 73728
  s_add_u32 s63, s63, 98304
  buffer_load_dwordx4 v23, s[16:19], s63 offen offset:0  lds
  buffer_load_dwordx4 v24, s[16:19], s63 offen offset:1024  lds
  buffer_load_dwordx4 v25, s[16:19], s63 offen offset:2048  lds
  s_add_u32 m0, s50, 86016
  s_add_u32 s64, s64, 98304
  buffer_load_dwordx4 v26, s[20:23], s64 offen offset:0  lds
  buffer_load_dwordx4 v27, s[20:23], s64 offen offset:1024  lds
  buffer_load_dwordx4 v28, s[20:23], s64 offen offset:2048  lds
  s_sub_u32 s49, s3, 17
  s_lshl2_add_u32 m0, s49, s32
  s_mov_b32 s38, 7369728
  s_mov_b32 s39, 0x20000
  s_mov_b32 s36, s6
  s_mov_b32 s37, s7
  s_mov_b32 s74, 0x2bd320
  s_mov_b32 s75, 0x972c4f
  s_mov_b32 s76, 0x6164
  s_mov_b32 s77, 0x83ae
  s_mov_b32 s78, 0x2db022
  s_mov_b32 s79, 0x992e51
  s_mov_b32 s80, 0xb524
  s_mov_b32 s81, 0xd566
  s_mov_b32 s82, 0x2fda53
  s_mov_b32 s83, 0xe13c5a
  s_mov_b32 s84, 0xd726
  s_mov_b32 s85, 0xe0b2
  s_mov_b32 s86, 0x3ddc55
  s_mov_b32 s87, 0x845c
  s_mov_b32 s88, 0x9428
  s_mov_b32 s89, 0xd97b
  s_mov_b32 s90, 0x95de5e
  s_mov_b32 s91, 0x2ac9
  s_mov_b32 s92, 0x8162
  s_mov_b32 s93, 0x967d
  s_movrels_b32 s72, s74
  s_mov_b32 s74, 0xf030100
  s_mov_b32 s75, 0xf030200
  s_mov_b32 s76, 0xf0201
  s_mov_b32 s77, 0xf0201
  s_mov_b32 s78, 0xf030100
  s_mov_b32 s79, 0xf030200
  s_mov_b32 s80, 0xf0201
  s_mov_b32 s81, 0xf0201
  s_mov_b32 s82, 0xf030100
  s_mov_b32 s83, 0xf030200
  s_mov_b32 s84, 0xf0201
  s_mov_b32 s85, 0xf0201
  s_mov_b32 s86, 0xf030100
  s_mov_b32 s87, 0xf0200
  s_mov_b32 s88, 0xf0201
  s_mov_b32 s89, 0xf0201
  s_mov_b32 s90, 0xf030100
  s_mov_b32 s91, 0xf0200
  s_mov_b32 s92, 0xf0201
  s_mov_b32 s93, 0xf0201
  s_movrels_b32 s73, s74
  s_waitcnt vmcnt(12)
  s_barrier
  s_setprio 1
  s_add_u32 m0, s50, 98304
  s_add_u32 s63, s63, 98304
  buffer_load_dwordx4 v23, s[16:19], s63 offen offset:0  lds
  buffer_load_dwordx4 v24, s[16:19], s63 offen offset:1024  lds
  buffer_load_dwordx4 v25, s[16:19], s63 offen offset:2048  lds
  s_add_u32 m0, s50, 110592
  s_add_u32 s64, s64, 98304
  buffer_load_dwordx4 v26, s[20:23], s64 offen offset:0  lds
  buffer_load_dwordx4 v27, s[20:23], s64 offen offset:1024  lds
  buffer_load_dwordx4 v28, s[20:23], s64 offen offset:2048  lds
  s_and_b32 s49, s73, 15
  s_cmp_lg_u32 s49, 0
  s_cbranch_scc1 L_T8_0
  s_bitcmp1_b32 s72, 0
  s_cselect_b32 s36, s8, s6
  s_cselect_b32 s37, s9, s7
  s_bfe_u32 s40, s73, 0x30004
  s_xor_b32 s40, s40, s33
  s_mul_i32 s40, s40, 384
  s_and_b32 s49, s72, 0xfe
  s_lshl_b32 s49, s49, 5
  s_lshr_b32 s72, s72, 8
  s_lshr_b32 s73, s73, 8
  s_or_b32 s73, s73, 0x0f000000
  v_add_u32 v34, s49, v14
  v_mul_u32_u24 v37, 43691, v34
  v_lshrrev_b32 v37, 17, v37
  v_mul_u32_u24 v37, 2688, v37
  v_lshl_add_u32 v34, v34, 7, v37
  buffer_load_dword v36, v34, s[36:39], s40 offen
L_T8_0:
  s_waitcnt vmcnt(6)
  s_barrier
  s_add_u32 m0, s50, 122880
  s_add_u32 s63, s63, 98304
  buffer_load_dwordx4 v23, s[16:19], s63 offen offset:0  lds
  buffer_load_dwordx4 v24, s[16:19], s63 offen offset:1024  lds
  buffer_load_dwordx4 v25, s[16:19], s63 offen offset:2048  lds
  s_add_u32 m0, s50, 135168
  s_add_u32 s64, s64, 98304
  buffer_load_dwordx4 v26, s[20:23], s64 offen offset:0  lds
  buffer_load_dwordx4 v27, s[20:23], s64 offen offset:1024  lds
  buffer_load_dwordx4 v28, s[20:23], s64 offen offset:2048  lds
  s_add_u32 m0, s50, 0
  s_add_u32 s63, s63, 98304
  buffer_load_dwordx4 v23, s[16:19], s63 offen offset:0  lds
  buffer_load_dwordx4 v24, s[16:19], s63 offen offset:1024  lds
  buffer_load_dwordx4 v25, s[16:19], s63 offen offset:2048  lds
  s_add_u32 m0, s50, 12288
  s_add_u32 s64, s64, 98304
  buffer_load_dwordx4 v26, s[20:23], s64 offen offset:0  lds
  buffer_load_dwordx4 v27, s[20:23], s64 offen offset:1024  lds
  buffer_load_dwordx4 v28, s[20:23], s64 offen offset:2048  lds
  s_and_b32 s49, s73, 15
  s_cmp_lg_u32 s49, 1
  s_cbranch_scc1 L_T8_1
  s_bitcmp1_b32 s72, 0
  s_cselect_b32 s36, s8, s6
  s_cselect_b32 s37, s9, s7
  s_bfe_u32 s40, s73, 0x30004
  s_xor_b32 s40, s40, s33
  s_mul_i32 s40, s40, 384
  s_and_b32 s49, s72, 0xfe
  s_lshl_b32 s49, s49, 5
  s_lshr_b32 s72, s72, 8
  s_lshr_b32 s73, s73, 8
  s_or_b32 s73, s73, 0x0f000000
  v_add_u32 v34, s49, v14
  v_mul_u32_u24 v37, 43691, v34
  v_lshrrev_b32 v37, 17, v37
  v_mul_u32_u24 v37, 2688, v37
  v_lshl_add_u32 v34, v34, 7, v37
  buffer_load_dword v36, v34, s[36:39], s40 offen
L_T8_1:
  s_waitcnt vmcnt(12)
  s_barrier
  s_add_u32 m0, s50, 24576
  s_add_u32 s63, s63, 98304
  buffer_load_dwordx4 v23, s[16:19], s63 offen offset:0  lds
  buffer_load_dwordx4 v24, s[16:19], s63 offen offset:1024  lds
  buffer_load_dwordx4 v25, s[16:19], s63 offen offset:2048  lds
  s_add_u32 m0, s50, 36864
  s_add_u32 s64, s64, 98304
  buffer_load_dwordx4 v26, s[20:23], s64 offen offset:0  lds
  buffer_load_dwordx4 v27, s[20:23], s64 offen offset:1024  lds
  buffer_load_dwordx4 v28, s[20:23], s64 offen offset:2048  lds
  s_and_b32 s49, s73, 15
  s_cmp_lg_u32 s49, 2
  s_cbranch_scc1 L_T8_2
  s_bitcmp1_b32 s72, 0
  s_cselect_b32 s36, s8, s6
  s_cselect_b32 s37, s9, s7
  s_bfe_u32 s40, s73, 0x30004
  s_xor_b32 s40, s40, s33
  s_mul_i32 s40, s40, 384
  s_and_b32 s49, s72, 0xfe
  s_lshl_b32 s49, s49, 5
  s_lshr_b32 s72, s72, 8
  s_lshr_b32 s73, s73, 8
  s_or_b32 s73, s73, 0x0f000000
  v_add_u32 v34, s49, v14
  v_mul_u32_u24 v37, 43691, v34
  v_lshrrev_b32 v37, 17, v37
  v_mul_u32_u24 v37, 2688, v37
  v_lshl_add_u32 v34, v34, 7, v37
  buffer_load_dword v36, v34, s[36:39], s40 offen
L_T8_2:
  s_waitcnt vmcnt(12)
  s_barrier
  s_add_u32 m0, s50, 49152
  s_add_u32 s63, s63, 98304
  buffer_load_dwordx4 v23, s[16:19], s63 offen offset:0  lds
  buffer_load_dwordx4 v24, s[16:19], s63 offen offset:1024  lds
  buffer_load_dwordx4 v25, s[16:19], s63 offen offset:2048  lds
  s_add_u32 m0, s50, 61440
  s_add_u32 s64, s64, 98304
  buffer_load_dwordx4 v26, s[20:23], s64 offen offset:0  lds
  buffer_load_dwordx4 v27, s[20:23], s64 offen offset:1024  lds
  buffer_load_dwordx4 v28, s[20:23], s64 offen offset:2048  lds
  s_and_b32 s49, s73, 15
  s_cmp_lg_u32 s49, 3
  s_cbranch_scc1 L_T8_3
  s_bitcmp1_b32 s72, 0
  s_cselect_b32 s36, s8, s6
  s_cselect_b32 s37, s9, s7
  s_bfe_u32 s40, s73, 0x30004
  s_xor_b32 s40, s40, s33
  s_mul_i32 s40, s40, 384
  s_and_b32 s49, s72, 0xfe
  s_lshl_b32 s49, s49, 5
  s_lshr_b32 s72, s72, 8
  s_lshr_b32 s73, s73, 8
  s_or_b32 s73, s73, 0x0f000000
  v_add_u32 v34, s49, v14
  v_mul_u32_u24 v37, 43691, v34
  v_lshrrev_b32 v37, 17, v37
  v_mul_u32_u24 v37, 2688, v37
  v_lshl_add_u32 v34, v34, 7, v37
  buffer_load_dword v36, v34, s[36:39], s40 offen
L_T8_3:
  s_waitcnt vmcnt(12)
  s_barrier
  s_add_u32 m0, s50, 73728
  s_add_u32 s63, s63, 98304
  buffer_load_dwordx4 v23, s[16:19], s63 offen offset:0  lds
  buffer_load_dwordx4 v24, s[16:19], s63 offen offset:1024  lds
  buffer_load_dwordx4 v25, s[16:19], s63 offen offset:2048  lds
  s_add_u32 m0, s50, 86016
  s_add_u32 s64, s64, 98304
  buffer_load_dwordx4 v26, s[20:23], s64 offen offset:0  lds
  buffer_load_dwordx4 v27, s[20:23], s64 offen offset:1024  lds
  buffer_load_dwordx4 v28, s[20:23], s64 offen offset:2048  lds
  s_waitcnt vmcnt(12)
  s_barrier
  s_add_u32 m0, s50, 98304
  s_add_u32 s63, s63, 98304
  buffer_load_dwordx4 v23, s[16:19], s63 offen offset:0  lds
  buffer_load_dwordx4 v24, s[16:19], s63 offen offset:1024  lds
  buffer_load_dwordx4 v25, s[16:19], s63 offen offset:2048  lds
  s_add_u32 m0, s50, 110592
  s_add_u32 s64, s64, 98304
  buffer_load_dwordx4 v26, s[20:23], s64 offen offset:0  lds
  buffer_load_dwordx4 v27, s[20:23], s64 offen offset:1024  lds
  buffer_load_dwordx4 v28, s[20:23], s64 offen offset:2048  lds
  s_waitcnt vmcnt(12)
  s_barrier
  s_add_u32 m0, s50, 122880
  s_add_u32 s63, s63, 98304
  buffer_load_dwordx4 v23, s[16:19], s63 offen offset:0  lds
  buffer_load_dwordx4 v24, s[16:19], s63 offen offset:1024  lds
  buffer_load_dwordx4 v25, s[16:19], s63 offen offset:2048  lds
  s_add_u32 m0, s50, 135168
  s_add_u32 s64, s64, 98304
  buffer_load_dwordx4 v26, s[20:23], s64 offen offset:0  lds
  buffer_load_dwordx4 v27, s[20:23], s64 offen offset:1024  lds
  buffer_load_dwordx4 v28, s[20:23], s64 offen offset:2048  lds
  s_waitcnt vmcnt(12)
  s_barrier
  s_add_u32 m0, s50, 12288
  s_add_u32 s64, s64, 98304
  buffer_load_dwordx4 v26, s[20:23], s64 offen offset:0  lds
  buffer_load_dwordx4 v27, s[20:23], s64 offen offset:1024  lds
  buffer_load_dwordx4 v28, s[20:23], s64 offen offset:2048  lds
  s_waitcnt vmcnt(9)
  s_barrier
  s_waitcnt vmcnt(3)
  s_barrier
  s_waitcnt vmcnt(0)
  s_barrier
  s_endpgm
.p2align 12
L_SH9:
  s_cbranch_execz RETH_R1
  s_add_u32 m0, s50, 36864
  s_add_u32 s63, s63, 98304
  buffer_load_dwordx4 v23, s[16:19], s63 offen offset:0  lds
  buffer_load_dwordx4 v24, s[16:19], s63 offen offset:1024  lds
  buffer_load_dwordx4 v25, s[16:19], s63 offen offset:2048  lds
  s_add_u32 m0, s50, 49152
  s_add_u32 s63, s63, 98304
  buffer_load_dwordx4 v23, s[16:19], s63 offen offset:0  lds
  buffer_load_dwordx4 v24, s[16:19], s63 offen offset:1024  lds
  buffer_load_dwordx4 v25, s[16:19], s63 offen offset:2048  lds
  s_add_u32 m0, s50, 61440
  s_add_u32 s63, s63, 98304
  buffer_load_dwordx4 v23, s[16:19], s63 offen offset:0  lds
  buffer_load_dwordx4 v24, s[16:19], s63 offen offset:1024  lds
  buffer_load_dwordx4 v25, s[16:19], s63 offen offset:2048  lds
  s_sub_u32 s49, s3, 22
  s_lshl2_add_u32 m0, s49, s32
  s_mov_b32 s38, 7369728
  s_mov_b32 s39, 0x20000
  s_mov_b32 s36, s6
  s_mov_b32 s37, s7
  s_mov_b32 s74, 0xad
  s_mov_b32 s75, 0x7f
  s_mov_b32 s76, 0x29
  s_mov_b32 s77, 0x0
  s_mov_b32 s78, 0xaf
  s_mov_b32 s79, 0xb1
  s_mov_b32 s80, 0x39
  s_mov_b32 s81, 0x0
  s_mov_b32 s82, 0x19
  s_mov_b32 s83, 0xb3
  s_mov_b32 s84, 0x3b
  s_mov_b32 s85, 0x0
  s_movrels_b32 s72, s74
  s_mov_b32 s74, 0xf01
  s_mov_b32 s75, 0xf02
  s_mov_b32 s76, 0xf03
  s_mov_b32 s77, 0xf
  s_mov_b32 s78, 0xf01
  s_mov_b32 s79, 0xf02
  s_mov_b32 s80, 0xf03
  s_mov_b32 s81, 0xf
  s_mov_b32 s82, 0xf01
  s_mov_b32 s83, 0xf02
  s_mov_b32 s84, 0xf03
  s_mov_b32 s85, 0xf
  s_movrels_b32 s73, s74
  s_add_u32 m0, s50, 73728
  s_add_u32 s64, s64, 98304
  buffer_load_dwordx4 v26, s[20:23], s64 offen offset:0  lds
  buffer_load_dwordx4 v27, s[20:23], s64 offen offset:1024  lds
  buffer_load_dwordx4 v28, s[20:23], s64 offen offset:2048  lds
  s_add_u32 m0, s50, 86016
  s_add_u32 s64, s64, 98304
  buffer_load_dwordx4 v26, s[20:23], s64 offen offset:0  lds
  buffer_load_dwordx4 v27, s[20:23], s64 offen offset:1024  lds
  buffer_load_dwordx4 v28, s[20:23], s64 offen offset:2048  lds
  s_waitcnt vmcnt(12)
  s_barrier
  s_setprio 1
  buffer_load_dword v36, v38, s[24:27], s68 offen
  s_add_u32 m0, s50, 98304
  s_add_u32 s63, s63, 98304
  buffer_load_dwordx4 v23, s[16:19], s63 offen offset:0  lds
  buffer_load_dwordx4 v24, s[16:19], s63 offen offset:1024  lds
  buffer_load_dwordx4 v25, s[16:19], s63 offen offset:2048  lds
  s_add_u32 m0, s50, 110592
  s_add_u32 s63, s63, 98304
  buffer_load_dwordx4 v23, s[16:19], s63 offen offset:0  lds
  buffer_load_dwordx4 v24, s[16:19], s63 offen offset:1024  lds
  buffer_load_dwordx4 v25, s[16:19], s63 offen offset:2048  lds
  s_waitcnt vmcnt(7)
  s_barrier
  s_add_u32 m0, s50, 122880
  s_add_u32 s64, s64, 98304
  buffer_load_dwordx4 v26, s[20:23], s64 offen offset:0  lds
  buffer_load_dwordx4 v27, s[20:23], s64 offen offset:1024  lds
  buffer_load_dwordx4 v28, s[20:23], s64 offen offset:2048  lds
  s_add_u32 m0, s50, 135168
  s_add_u32 s64, s64, 98304
  buffer_load_dwordx4 v26, s[20:23], s64 offen offset:0  lds
  buffer_load_dwordx4 v27, s[20:23], s64 offen offset:1024  lds
  buffer_load_dwordx4 v28, s[20:23], s64 offen offset:2048  lds
  s_add_u32 m0, s50, 0
  s_add_u32 s63, s63, 98304
  buffer_load_dwordx4 v23, s[16:19], s63 offen offset:0  lds
  buffer_load_dwordx4 v24, s[16:19], s63 offen offset:1024  lds
  buffer_load_dwordx4 v25, s[16:19], s63 offen offset:2048  lds
  s_add_u32 m0, s50, 12288
  s_add_u32 s63, s63, 98304
  buffer_load_dwordx4 v23, s[16:19], s63 offen offset:0  lds
  buffer_load_dwordx4 v24, s[16:19], s63 offen offset:1024  lds
  buffer_load_dwordx4 v25, s[16:19], s63 offen offset:2048  lds
  s_and_b32 s49, s73, 15
  s_cmp_lg_u32 s49, 1
  s_cbranch_scc1 L_T9_1
  s_bitcmp1_b32 s72, 0
  s_cselect_b32 s36, s8, s6
  s_cselect_b32 s37, s9, s7
  s_bfe_u32 s40, s73, 0x30004
  s_xor_b32 s40, s40, s33
  s_mul_i32 s40, s40, 384
  s_and_b32 s49, s72, 0xfe
  s_lshl_b32 s49, s49, 5
  s_lshr_b32 s72, s72, 8
  s_lshr_b32 s73, s73, 8
  s_or_b32 s73, s73, 0x0f000000
  v_add_u32 v34, s49, v14
  v_mul_u32_u24 v37, 43691, v34
  v_lshrrev_b32 v37, 17, v37
  v_mul_u32_u24 v37, 2688, v37
  v_lshl_add_u32 v34, v34, 7, v37
  buffer_load_dword v36, v34, s[36:39], s40 offen
L_T9_1:
  s_waitcnt vmcnt(6)
  s_barrier
  s_add_u32 m0, s50, 24576
  s_add_u32 s64, s64, 98304
  buffer_load_dwordx4 v26, s[20:23], s64 offen offset:0  lds
  buffer_load_dwordx4 v27, s[20:23], s64 offen offset:1024  lds
  buffer_load_dwordx4 v28, s[20:23], s64 offen offset:2048  lds
  s_add_u32 m0, s50, 36864
  s_add_u32 s64, s64, 98304
  buffer_load_dwordx4 v26, s[20:23], s64 offen offset:0  lds
  buffer_load_dwordx4 v27, s[20:23], s64 offen offset:1024  lds
  buffer_load_dwordx4 v28, s[20:23], s64 offen offset:2048  lds
  s_add_u32 m0, s50, 49152
  s_add_u32 s63, s63, 98304
  buffer_load_dwordx4 v23, s[16:19], s63 offen offset:0  lds
  buffer_load_dwordx4 v24, s[16:19], s63 offen offset:1024  lds
  buffer_load_dwordx4 v25, s[16:19], s63 offen offset:2048  lds
  s_add_u32 m0, s50, 61440
  s_add_u32 s63, s63, 98304
  buffer_load_dwordx4 v23, s[16:19], s63 offen offset:0  lds
  buffer_load_dwordx4 v24, s[16:19], s63 offen offset:1024  lds
  buffer_load_dwordx4 v25, s[16:19], s63 offen offset:2048  lds
  s_and_b32 s49, s73, 15
  s_cmp_lg_u32 s49, 2
  s_cbranch_scc1 L_T9_2
  s_bitcmp1_b32 s72, 0
  s_cselect_b32 s36, s8, s6
  s_cselect_b32 s37, s9, s7
  s_bfe_u32 s40, s73, 0x30004
  s_xor_b32 s40, s40, s33
  s_mul_i32 s40, s40, 384
  s_and_b32 s49, s72, 0xfe
  s_lshl_b32 s49, s49, 5
  s_lshr_b32 s72, s72, 8
  s_lshr_b32 s73, s73, 8
  s_or_b32 s73, s73, 0x0f000000
  v_add_u32 v34, s49, v14
  v_mul_u32_u24 v37, 43691, v34
  v_lshrrev_b32 v37, 17, v37
  v_mul_u32_u24 v37, 2688, v37
  v_lshl_add_u32 v34, v34, 7, v37
  buffer_load_dword v36, v34, s[36:39], s40 offen
L_T9_2:
  s_waitcnt vmcnt(6)
  s_barrier
  s_add_u32 m0, s50, 73728
  s_add_u32 s64, s64, 98304
  buffer_load_dwordx4 v26, s[20:23], s64 offen offset:0  lds
  buffer_load_dwordx4 v27, s[20:23], s64 offen offset:1024  lds
  buffer_load_dwordx4 v28, s[20:23], s64 offen offset:2048  lds
  s_add_u32 m0, s50, 86016
  s_add_u32 s64, s64, 98304
  buffer_load_dwordx4 v26, s[20:23], s64 offen offset:0  lds
  buffer_load_dwordx4 v27, s[20:23], s64 offen offset:1024  lds
  buffer_load_dwordx4 v28, s[20:23], s64 offen offset:2048  lds
  s_add_u32 m0, s50, 98304
  s_add_u32 s63, s63, 98304
  buffer_load_dwordx4 v23, s[16:19], s63 offen offset:0  lds
  buffer_load_dwordx4 v24, s[16:19], s63 offen offset:1024  lds
  buffer_load_dwordx4 v25, s[16:19], s63 offen offset:2048  lds
  s_add_u32 m0, s50, 110592
  s_add_u32 s63, s63, 98304
  buffer_load_dwordx4 v23, s[16:19], s63 offen offset:0  lds
  buffer_load_dwordx4 v24, s[16:19], s63 offen offset:1024  lds
  buffer_load_dwordx4 v25, s[16:19], s63 offen offset:2048  lds
  s_and_b32 s49, s73, 15
  s_cmp_lg_u32 s49, 3
  s_cbranch_scc1 L_T9_3
  s_bitcmp1_b32 s72, 0
  s_cselect_b32 s36, s8, s6
  s_cselect_b32 s37, s9, s7
  s_bfe_u32 s40, s73, 0x30004
  s_xor_b32 s40, s40, s33
  s_mul_i32 s40, s40, 384
  s_and_b32 s49, s72, 0xfe
  s_lshl_b32 s49, s49, 5
  s_lshr_b32 s72, s72, 8
  s_lshr_b32 s73, s73, 8
  s_or_b32 s73, s73, 0x0f000000
  v_add_u32 v34, s49, v14
  v_mul_u32_u24 v37, 43691, v34
  v_lshrrev_b32 v37, 17, v37
  v_mul_u32_u24 v37, 2688, v37
  v_lshl_add_u32 v34, v34, 7, v37
  buffer_load_dword v36, v34, s[36:39], s40 offen
L_T9_3:
  s_waitcnt vmcnt(6)
  s_barrier
  s_add_u32 m0, s50, 122880
  s_add_u32 s64, s64, 98304
  buffer_load_dwordx4 v26, s[20:23], s64 offen offset:0  lds
  buffer_load_dwordx4 v27, s[20:23], s64 offen offset:1024  lds
  buffer_load_dwordx4 v28, s[20:23], s64 offen offset:2048  lds
  s_add_u32 m0, s50, 135168
  s_add_u32 s64, s64, 98304
  buffer_load_dwordx4 v26, s[20:23], s64 offen offset:0  lds
  buffer_load_dwordx4 v27, s[20:23], s64 offen offset:1024  lds
  buffer_load_dwordx4 v28, s[20:23], s64 offen offset:2048  lds
  s_add_u32 m0, s50, 0
  s_add_u32 s63, s63, 98304
  buffer_load_dwordx4 v23, s[16:19], s63 offen offset:0  lds
  buffer_load_dwordx4 v24, s[16:19], s63 offen offset:1024  lds
  buffer_load_dwordx4 v25, s[16:19], s63 offen offset:2048  lds
  s_add_u32 m0, s50, 12288
  s_add_u32 s63, s63, 98304
  buffer_load_dwordx4 v23, s[16:19], s63 offen offset:0  lds
  buffer_load_dwordx4 v24, s[16:19], s63 offen offset:1024  lds
  buffer_load_dwordx4 v25, s[16:19], s63 offen offset:2048  lds
  s_waitcnt vmcnt(6)
  s_barrier
  s_add_u32 m0, s50, 24576
  s_add_u32 s64, s64, 98304
  buffer_load_dwordx4 v26, s[20:23], s64 offen offset:0  lds
  buffer_load_dwordx4 v27, s[20:23], s64 offen offset:1024  lds
  buffer_load_dwordx4 v28, s[20:23], s64 offen offset:2048  lds
  s_add_u32 m0, s50, 36864
  s_add_u32 s64, s64, 98304
  buffer_load_dwordx4 v26, s[20:23], s64 offen offset:0  lds
  buffer_load_dwordx4 v27, s[20:23], s64 offen offset:1024  lds
  buffer_load_dwordx4 v28, s[20:23], s64 offen offset:2048  lds
  s_add_u32 m0, s50, 49152
  s_add_u32 s63, s63, 98304
  buffer_load_dwordx4 v23, s[16:19], s63 offen offset:0  lds
  buffer_load_dwordx4 v24, s[16:19], s63 offen offset:1024  lds
  buffer_load_dwordx4 v25, s[16:19], s63 offen offset:2048  lds
  s_waitcnt vmcnt(3)
  s_barrier
  s_add_u32 m0, s50, 73728
  s_add_u32 s64, s64, 98304
  buffer_load_dwordx4 v26, s[20:23], s64 offen offset:0  lds
  buffer_load_dwordx4 v27, s[20:23], s64 offen offset:1024  lds
  buffer_load_dwordx4 v28, s[20:23], s64 offen offset:2048  lds
  s_add_u32 m0, s50, 86016
  s_add_u32 s64, s64, 98304
  buffer_load_dwordx4 v26, s[20:23], s64 offen offset:0  lds
  buffer_load_dwordx4 v27, s[20:23], s64 offen offset:1024  lds
  buffer_load_dwordx4 v28, s[20:23], s64 offen offset:2048  lds
  s_waitcnt vmcnt(0)
  s_barrier
  s_add_u32 m0, s50, 122880
  s_add_u32 s64, s64, 98304
  buffer_load_dwordx4 v26, s[20:23], s64 offen offset:0  lds
  buffer_load_dwordx4 v27, s[20:23], s64 offen offset:1024  lds
  buffer_load_dwordx4 v28, s[20:23], s64 offen offset:2048  lds
  s_waitcnt vmcnt(0)
  s_barrier
  s_endpgm
L_SH10:
  s_cbranch_execz RETH_R1
  s_add_u32 m0, s50, 36864
  s_add_u32 s63, s63, 98304
  buffer_load_dwordx4 v23, s[16:19], s63 offen offset:0  lds
  buffer_load_dwordx4 v24, s[16:19], s63 offen offset:1024  lds
  buffer_load_dwordx4 v25, s[16:19], s63 offen offset:2048  lds
  s_add_u32 m0, s50, 49152
  s_add_u32 s63, s63, 98304
  buffer_load_dwordx4 v23, s[16:19], s63 offen offset:0  lds
  buffer_load_dwordx4 v24, s[16:19], s63 offen offset:1024  lds
  buffer_load_dwordx4 v25, s[16:19], s63 offen offset:2048  lds
  s_add_u32 m0, s50, 61440
  s_add_u32 s63, s63, 98304
  buffer_load_dwordx4 v23, s[16:19], s63 offen offset:0  lds
  buffer_load_dwordx4 v24, s[16:19], s63 offen offset:1024  lds
  buffer_load_dwordx4 v25, s[16:19], s63 offen offset:2048  lds
  s_sub_u32 s49, s3, 25
  s_lshl2_add_u32 m0, s49, s32
  s_mov_b32 s38, 7369728
  s_mov_b32 s39, 0x20000
  s_mov_b32 s36, s6
  s_mov_b32 s37, s7
  s_mov_b32 s74, 0x1b
  s_mov_b32 s75, 0x38
  s_mov_b32 s76, 0x63
  s_mov_b32 s77, 0x0
  s_movrels_b32 s72, s74
  s_mov_b32 s74, 0xf01
  s_mov_b32 s75, 0xf02
  s_mov_b32 s76, 0xf03
  s_mov_b32 s77, 0xf
  s_movrels_b32 s73, s74
  s_add_u32 m0, s50, 73728
  s_add_u32 s64, s64, 98304
  buffer_load_dwordx4 v26, s[20:23], s64 offen offset:0  lds
  buffer_load_dwordx4 v27, s[20:23], s64 offen offset:1024  lds
  buffer_load_dwordx4 v28, s[20:23], s64 offen offset:2048  lds
  s_add_u32 m0, s50, 86016
  s_add_u32 s64, s64, 98304
  buffer_load_dwordx4 v26, s[20:23], s64 offen offset:0  lds
  buffer_load_dwordx4 v27, s[20:23], s64 offen offset:1024  lds
  buffer_load_dwordx4 v28, s[20:23], s64 offen offset:2048  lds
  s_waitcnt vmcnt(12)
  s_barrier
  s_setprio 1
  buffer_load_dword v36, v38, s[24:27], s68 offen
  s_add_u32 m0, s50, 98304
  s_add_u32 s63, s63, 98304
  buffer_load_dwordx4 v23, s[16:19], s63 offen offset:0  lds
  buffer_load_dwordx4 v24, s[16:19], s63 offen offset:1024  lds
  buffer_load_dwordx4 v25, s[16:19], s63 offen offset:2048  lds
  s_add_u32 m0, s50, 110592
  s_add_u32 s63, s63, 98304
  buffer_load_dwordx4 v23, s[16:19], s63 offen offset:0  lds
  buffer_load_dwordx4 v24, s[16:19], s63 offen offset:1024  lds
  buffer_load_dwordx4 v25, s[16:19], s63 offen offset:2048  lds
  s_waitcnt vmcnt(7)
  s_barrier
  s_add_u32 m0, s50, 122880
  s_add_u32 s64, s64, 98304
  buffer_load_dwordx4 v26, s[20:23], s64 offen offset:0  lds
  buffer_load_dwordx4 v27, s[20:23], s64 offen offset:1024  lds
  buffer_load_dwordx4 v28, s[20:23], s64 offen offset:2048  lds
  s_add_u32 m0, s50, 135168
  s_add_u32 s64, s64, 98304
  buffer_load_dwordx4 v26, s[20:23], s64 offen offset:0  lds
  buffer_load_dwordx4 v27, s[20:23], s64 offen offset:1024  lds
  buffer_load_dwordx4 v28, s[20:23], s64 offen offset:2048  lds
  s_add_u32 m0, s50, 0
  s_add_u32 s63, s63, 98304
  buffer_load_dwordx4 v23, s[16:19], s63 offen offset:0  lds
  buffer_load_dwordx4 v24, s[16:19], s63 offen offset:1024  lds
  buffer_load_dwordx4 v25, s[16:19], s63 offen offset:2048  lds
  s_add_u32 m0, s50, 12288
  s_add_u32 s63, s63, 98304
  buffer_load_dwordx4 v23, s[16:19], s63 offen offset:0  lds
  buffer_load_dwordx4 v24, s[16:19], s63 offen offset:1024  lds
  buffer_load_dwordx4 v25, s[16:19], s63 offen offset:2048  lds
  s_and_b32 s49, s73, 15
  s_cmp_lg_u32 s49, 1
  s_cbranch_scc1 L_T10_1
  s_bitcmp1_b32 s72, 0
  s_cselect_b32 s36, s8, s6
  s_cselect_b32 s37, s9, s7
  s_bfe_u32 s40, s73, 0x30004
  s_xor_b32 s40, s40, s33
  s_mul_i32 s40, s40, 384
  s_and_b32 s49, s72, 0xfe
  s_lshl_b32 s49, s49, 5
  s_lshr_b32 s72, s72, 8
  s_lshr_b32 s73, s73, 8
  s_or_b32 s73, s73, 0x0f000000
  v_add_u32 v34, s49, v14
  v_mul_u32_u24 v37, 43691, v34
  v_lshrrev_b32 v37, 17, v37
  v_mul_u32_u24 v37, 2688, v37
  v_lshl_add_u32 v34, v34, 7, v37
  buffer_load_dword v36, v34, s[36:39], s40 offen
L_T10_1:
  s_waitcnt vmcnt(6)
  s_barrier
  s_add_u32 m0, s50, 24576
  s_add_u32 s64, s64, 98304
  buffer_load_dwordx4 v26, s[20:23], s64 offen offset:0  lds
  buffer_load_dwordx4 v27, s[20:23], s64 offen offset:1024  lds
  buffer_load_dwordx4 v28, s[20:23], s64 offen offset:2048  lds
  s_add_u32 m0, s50, 36864
  s_add_u32 s64, s64, 98304
  buffer_load_dwordx4 v26, s[20:23], s64 offen offset:0  lds
  buffer_load_dwordx4 v27, s[20:23], s64 offen offset:1024  lds
  buffer_load_dwordx4 v28, s[20:23], s64 offen offset:2048  lds
  s_add_u32 m0, s50, 49152
  s_add_u32 s63, s63, 98304
  buffer_load_dwordx4 v23, s[16:19], s63 offen offset:0  lds
  buffer_load_dwordx4 v24, s[16:19], s63 offen offset:1024  lds
  buffer_load_dwordx4 v25, s[16:19], s63 offen offset:2048  lds
  s_add_u32 m0, s50, 61440
  s_add_u32 s63, s63, 98304
  buffer_load_dwordx4 v23, s[16:19], s63 offen offset:0  lds
  buffer_load_dwordx4 v24, s[16:19], s63 offen offset:1024  lds
  buffer_load_dwordx4 v25, s[16:19], s63 offen offset:2048  lds
  s_and_b32 s49, s73, 15
  s_cmp_lg_u32 s49, 2
  s_cbranch_scc1 L_T10_2
  s_bitcmp1_b32 s72, 0
  s_cselect_b32 s36, s8, s6
  s_cselect_b32 s37, s9, s7
  s_bfe_u32 s40, s73, 0x30004
  s_xor_b32 s40, s40, s33
  s_mul_i32 s40, s40, 384
  s_and_b32 s49, s72, 0xfe
  s_lshl_b32 s49, s49, 5
  s_lshr_b32 s72, s72, 8
  s_lshr_b32 s73, s73, 8
  s_or_b32 s73, s73, 0x0f000000
  v_add_u32 v34, s49, v14
  v_mul_u32_u24 v37, 43691, v34
  v_lshrrev_b32 v37, 17, v37
  v_mul_u32_u24 v37, 2688, v37
  v_lshl_add_u32 v34, v34, 7, v37
  buffer_load_dword v36, v34, s[36:39], s40 offen
L_T10_2:
  s_waitcnt vmcnt(6)
  s_barrier
  s_add_u32 m0, s50, 73728
  s_add_u32 s64, s64, 98304
  buffer_load_dwordx4 v26, s[20:23], s64 offen offset:0  lds
  buffer_load_dwordx4 v27, s[20:23], s64 offen offset:1024  lds
  buffer_load_dwordx4 v28, s[20:23], s64 offen offset:2048  lds
  s_add_u32 m0, s50, 86016
  s_add_u32 s64, s64, 98304
  buffer_load_dwordx4 v26, s[20:23], s64 offen offset:0  lds
  buffer_load_dwordx4 v27, s[20:23], s64 offen offset:1024  lds
  buffer_load_dwordx4 v28, s[20:23], s64 offen offset:2048  lds
  s_add_u32 m0, s50, 98304
  s_add_u32 s63, s63, 98304
  buffer_load_dwordx4 v23, s[16:19], s63 offen offset:0  lds
  buffer_load_dwordx4 v24, s[16:19], s63 offen offset:1024  lds
  buffer_load_dwordx4 v25, s[16:19], s63 offen offset:2048  lds
  s_add_u32 m0, s50, 110592
  s_add_u32 s63, s63, 98304
  buffer_load_dwordx4 v23, s[16:19], s63 offen offset:0  lds
  buffer_load_dwordx4 v24, s[16:19], s63 offen offset:1024  lds
  buffer_load_dwordx4 v25, s[16:19], s63 offen offset:2048  lds
  s_and_b32 s49, s73, 15
  s_cmp_lg_u32 s49, 3
  s_cbranch_scc1 L_T10_3
  s_bitcmp1_b32 s72, 0
  s_cselect_b32 s36, s8, s6
  s_cselect_b32 s37, s9, s7
  s_bfe_u32 s40, s73, 0x30004
  s_xor_b32 s40, s40, s33
  s_mul_i32 s40, s40, 384
  s_and_b32 s49, s72, 0xfe
  s_lshl_b32 s49, s49, 5
  s_lshr_b32 s72, s72, 8
  s_lshr_b32 s73, s73, 8
  s_or_b32 s73, s73, 0x0f000000
  v_add_u32 v34, s49, v14
  v_mul_u32_u24 v37, 43691, v34
  v_lshrrev_b32 v37, 17, v37
  v_mul_u32_u24 v37, 2688, v37
  v_lshl_add_u32 v34, v34, 7, v37
  buffer_load_dword v36, v34, s[36:39], s40 offen
L_T10_3:
  s_waitcnt vmcnt(6)
  s_barrier
  s_add_u32 m0, s50, 122880
  s_add_u32 s64, s64, 98304
  buffer_load_dwordx4 v26, s[20:23], s64 offen offset:0  lds
  buffer_load_dwordx4 v27, s[20:23], s64 offen offset:1024  lds
  buffer_load_dwordx4 v28, s[20:23], s64 offen offset:2048  lds
  s_add_u32 m0, s50, 135168
  s_add_u32 s64, s64, 98304
  buffer_load_dwordx4 v26, s[20:23], s64 offen offset:0  lds
  buffer_load_dwordx4 v27, s[20:23], s64 offen offset:1024  lds
  buffer_load_dwordx4 v28, s[20:23], s64 offen offset:2048  lds
  s_add_u32 m0, s50, 0
  s_add_u32 s63, s63, 98304
  buffer_load_dwordx4 v23, s[16:19], s63 offen offset:0  lds
  buffer_load_dwordx4 v24, s[16:19], s63 offen offset:1024  lds
  buffer_load_dwordx4 v25, s[16:19], s63 offen offset:2048  lds
  s_add_u32 m0, s50, 12288
  s_add_u32 s63, s63, 98304
  buffer_load_dwordx4 v23, s[16:19], s63 offen offset:0  lds
  buffer_load_dwordx4 v24, s[16:19], s63 offen offset:1024  lds
  buffer_load_dwordx4 v25, s[16:19], s63 offen offset:2048  lds
  s_waitcnt vmcnt(6)
  s_barrier
  s_add_u32 m0, s50, 24576
  s_add_u32 s64, s64, 98304
  buffer_load_dwordx4 v26, s[20:23], s64 offen offset:0  lds
  buffer_load_dwordx4 v27, s[20:23], s64 offen offset:1024  lds
  buffer_load_dwordx4 v28, s[20:23], s64 offen offset:2048  lds
  s_add_u32 m0, s50, 36864
  s_add_u32 s64, s64, 98304
  buffer_load_dwordx4 v26, s[20:23], s64 offen offset:0  lds
  buffer_load_dwordx4 v27, s[20:23], s64 offen offset:1024  lds
  buffer_load_dwordx4 v28, s[20:23], s64 offen offset:2048  lds
  s_add_u32 m0, s50, 49152
  s_add_u32 s63, s63, 98304
  buffer_load_dwordx4 v23, s[16:19], s63 offen offset:0  lds
  buffer_load_dwordx4 v24, s[16:19], s63 offen offset:1024  lds
  buffer_load_dwordx4 v25, s[16:19], s63 offen offset:2048  lds
  s_add_u32 m0, s50, 61440
  s_add_u32 s63, s63, 98304
  buffer_load_dwordx4 v23, s[16:19], s63 offen offset:0  lds
  buffer_load_dwordx4 v24, s[16:19], s63 offen offset:1024  lds
  buffer_load_dwordx4 v25, s[16:19], s63 offen offset:2048  lds
  s_waitcnt vmcnt(6)
  s_barrier
  s_add_u32 m0, s50, 73728
  s_add_u32 s64, s64, 98304
  buffer_load_dwordx4 v26, s[20:23], s64 offen offset:0  lds
  buffer_load_dwordx4 v27, s[20:23], s64 offen offset:1024  lds
  buffer_load_dwordx4 v28, s[20:23], s64 offen offset:2048  lds
  s_add_u32 m0, s50, 86016
  s_add_u32 s64, s64, 98304
  buffer_load_dwordx4 v26, s[20:23], s64 offen offset:0  lds
  buffer_load_dwordx4 v27, s[20:23], s64 offen offset:1024  lds
  buffer_load_dwordx4 v28, s[20:23], s64 offen offset:2048  lds
  s_waitcnt vmcnt(0)
  s_barrier
  s_add_u32 m0, s50, 122880
  s_add_u32 s64, s64, 98304
  buffer_load_dwordx4 v26, s[20:23], s64 offen offset:0  lds
  buffer_load_dwordx4 v27, s[20:23], s64 offen offset:1024  lds
  buffer_load_dwordx4 v28, s[20:23], s64 offen offset:2048  lds
  s_add_u32 m0, s50, 135168
  s_add_u32 s64, s64, 98304
  buffer_load_dwordx4 v26, s[20:23], s64 offen offset:0  lds
  buffer_load_dwordx4 v27, s[20:23], s64 offen offset:1024  lds
  buffer_load_dwordx4 v28, s[20:23], s64 offen offset:2048  lds
  s_waitcnt vmcnt(0)
  s_barrier
  s_endpgm
.p2align 12
L_SH12:
  s_cbranch_execz RETH_R1
  s_add_u32 m0, s50, 36864
  s_add_u32 s63, s63, 98304
  buffer_load_dwordx4 v23, s[16:19], s63 offen offset:0  lds
  buffer_load_dwordx4 v24, s[16:19], s63 offen offset:1024  lds
  buffer_load_dwordx4 v25, s[16:19], s63 offen offset:2048  lds
  s_add_u32 m0, s50, 49152
  s_add_u32 s63, s63, 98304
  buffer_load_dwordx4 v23, s[16:19], s63 offen offset:0  lds
  buffer_load_dwordx4 v24, s[16:19], s63 offen offset:1024  lds
  buffer_load_dwordx4 v25, s[16:19], s63 offen offset:2048  lds
  s_add_u32 m0, s50, 61440
  s_add_u32 s63, s63, 98304
  buffer_load_dwordx4 v23, s[16:19], s63 offen offset:0  lds
  buffer_load_dwordx4 v24, s[16:19], s63 offen offset:1024  lds
  buffer_load_dwordx4 v25, s[16:19], s63 offen offset:2048  lds
  s_sub_u32 s49, s3, 29
  s_lshl2_add_u32 m0, s49, s32
  s_mov_b32 s38, 7369728
  s_mov_b32 s39, 0x20000
  s_mov_b32 s36, s6
  s_mov_b32 s37, s7
  s_mov_b32 s74, 0x5b
  s_mov_b32 s75, 0x23
  s_mov_b32 s76, 0xdd
  s_mov_b32 s77, 0x0
  s_mov_b32 s78, 0xcf
  s_mov_b32 s79, 0x5d
  s_mov_b32 s80, 0xdf
  s_mov_b32 s81, 0x0
  s_mov_b32 s82, 0xd1
  s_mov_b32 s83, 0x5f
  s_mov_b32 s84, 0x85
  s_mov_b32 s85, 0x0
  s_movrels_b32 s72, s74
  s_mov_b32 s74, 0xf01
  s_mov_b32 s75, 0xf02
  s_mov_b32 s76, 0xf03
  s_mov_b32 s77, 0xf
  s_mov_b32 s78, 0xf01
  s_mov_b32 s79, 0xf02
  s_mov_b32 s80, 0xf03
  s_mov_b32 s81, 0xf
  s_mov_b32 s82, 0xf01
  s_mov_b32 s83, 0xf02
  s_mov_b32 s84, 0xf03
  s_mov_b32 s85, 0xf
  s_movrels_b32 s73, s74
  s_add_u32 m0, s50, 73728
  s_add_u32 s64, s64, 98304
  buffer_load_dwordx4 v26, s[20:23], s64 offen offset:0  lds
  buffer_load_dwordx4 v27, s[20:23], s64 offen offset:1024  lds
  buffer_load_dwordx4 v28, s[20:23], s64 offen offset:2048  lds
  s_add_u32 m0, s50, 86016
  s_add_u32 s64, s64, 98304
  buffer_load_dwordx4 v26, s[20:23], s64 offen offset:0  lds
  buffer_load_dwordx4 v27, s[20:23], s64 offen offset:1024  lds
  buffer_load_dwordx4 v28, s[20:23], s64 offen offset:2048  lds
  s_waitcnt vmcnt(12)
  s_barrier
  s_setprio 1
  buffer_load_dword v36, v38, s[24:27], s68 offen
  s_add_u32 m0, s50, 98304
  s_add_u32 s63, s63, 98304
  buffer_load_dwordx4 v23, s[16:19], s63 offen offset:0  lds
  buffer_load_dwordx4 v24, s[16:19], s63 offen offset:1024  lds
  buffer_load_dwordx4 v25, s[16:19], s63 offen offset:2048  lds
  s_add_u32 m0, s50, 110592
  s_add_u32 s63, s63, 98304
  buffer_load_dwordx4 v23, s[16:19], s63 offen offset:0  lds
  buffer_load_dwordx4 v24, s[16:19], s63 offen offset:1024  lds
  buffer_load_dwordx4 v25, s[16:19], s63 offen offset:2048  lds
  s_waitcnt vmcnt(7)
  s_barrier
  s_add_u32 m0, s50, 122880
  s_add_u32 s64, s64, 98304
  buffer_load_dwordx4 v26, s[20:23], s64 offen offset:0  lds
  buffer_load_dwordx4 v27, s[20:23], s64 offen offset:1024  lds
  buffer_load_dwordx4 v28, s[20:23], s64 offen offset:2048  lds
  s_add_u32 m0, s50, 135168
  s_add_u32 s64, s64, 98304
  buffer_load_dwordx4 v26, s[20:23], s64 offen offset:0  lds
  buffer_load_dwordx4 v27, s[20:23], s64 offen offset:1024  lds
  buffer_load_dwordx4 v28, s[20:23], s64 offen offset:2048  lds
  s_add_u32 m0, s50, 0
  s_add_u32 s63, s63, 98304
  buffer_load_dwordx4 v23, s[16:19], s63 offen offset:0  lds
  buffer_load_dwordx4 v24, s[16:19], s63 offen offset:1024  lds
  buffer_load_dwordx4 v25, s[16:19], s63 offen offset:2048  lds
  s_add_u32 m0, s50, 12288
  s_add_u32 s63, s63, 98304
  buffer_load_dwordx4 v23, s[16:19], s63 offen offset:0  lds
  buffer_load_dwordx4 v24, s[16:19], s63 offen offset:1024  lds
  buffer_load_dwordx4 v25, s[16:19], s63 offen offset:2048  lds
  s_and_b32 s49, s73, 15
  s_cmp_lg_u32 s49, 1
  s_cbranch_scc1 L_T12_1
  s_bitcmp1_b32 s72, 0
  s_cselect_b32 s36, s8, s6
  s_cselect_b32 s37, s9, s7
  s_bfe_u32 s40, s73, 0x30004
  s_xor_b32 s40, s40, s33
  s_mul_i32 s40, s40, 384
  s_and_b32 s49, s72, 0xfe
  s_lshl_b32 s49, s49, 5
  s_lshr_b32 s72, s72, 8
  s_lshr_b32 s73, s73, 8
  s_or_b32 s73, s73, 0x0f000000
  v_add_u32 v34, s49, v14
  v_mul_u32_u24 v37, 43691, v34
  v_lshrrev_b32 v37, 17, v37
  v_mul_u32_u24 v37, 2688, v37
  v_lshl_add_u32 v34, v34, 7, v37
  buffer_load_dword v36, v34, s[36:39], s40 offen
L_T12_1:
  s_waitcnt vmcnt(6)
  s_barrier
  s_add_u32 m0, s50, 24576
  s_add_u32 s64, s64, 98304
  buffer_load_dwordx4 v26, s[20:23], s64 offen offset:0  lds
  buffer_load_dwordx4 v27, s[20:23], s64 offen offset:1024  lds
  buffer_load_dwordx4 v28, s[20:23], s64 offen offset:2048  lds
  s_add_u32 m0, s50, 36864
  s_add_u32 s64, s64, 98304
  buffer_load_dwordx4 v26, s[20:23], s64 offen offset:0  lds
  buffer_load_dwordx4 v27, s[20:23], s64 offen offset:1024  lds
  buffer_load_dwordx4 v28, s[20:23], s64 offen offset:2048  lds
  s_add_u32 m0, s50, 49152
  s_add_u32 s63, s63, 98304
  buffer_load_dwordx4 v23, s[16:19], s63 offen offset:0  lds
  buffer_load_dwordx4 v24, s[16:19], s63 offen offset:1024  lds
  buffer_load_dwordx4 v25, s[16:19], s63 offen offset:2048  lds
  s_add_u32 m0, s50, 61440
  s_add_u32 s63, s63, 98304
  buffer_load_dwordx4 v23, s[16:19], s63 offen offset:0  lds
  buffer_load_dwordx4 v24, s[16:19], s63 offen offset:1024  lds
  buffer_load_dwordx4 v25, s[16:19], s63 offen offset:2048  lds
  s_and_b32 s49, s73, 15
  s_cmp_lg_u32 s49, 2
  s_cbranch_scc1 L_T12_2
  s_bitcmp1_b32 s72, 0
  s_cselect_b32 s36, s8, s6
  s_cselect_b32 s37, s9, s7
  s_bfe_u32 s40, s73, 0x30004
  s_xor_b32 s40, s40, s33
  s_mul_i32 s40, s40, 384
  s_and_b32 s49, s72, 0xfe
  s_lshl_b32 s49, s49, 5
  s_lshr_b32 s72, s72, 8
  s_lshr_b32 s73, s73, 8
  s_or_b32 s73, s73, 0x0f000000
  v_add_u32 v34, s49, v14
  v_mul_u32_u24 v37, 43691, v34
  v_lshrrev_b32 v37, 17, v37
  v_mul_u32_u24 v37, 2688, v37
  v_lshl_add_u32 v34, v34, 7, v37
  buffer_load_dword v36, v34, s[36:39], s40 offen
L_T12_2:
  s_waitcnt vmcnt(6)
  s_barrier
  s_add_u32 m0, s50, 73728
  s_add_u32 s64, s64, 98304
  buffer_load_dwordx4 v26, s[20:23], s64 offen offset:0  lds
  buffer_load_dwordx4 v27, s[20:23], s64 offen offset:1024  lds
  buffer_load_dwordx4 v28, s[20:23], s64 offen offset:2048  lds
  s_add_u32 m0, s50, 86016
  s_add_u32 s64, s64, 98304
  buffer_load_dwordx4 v26, s[20:23], s64 offen offset:0  lds
  buffer_load_dwordx4 v27, s[20:23], s64 offen offset:1024  lds
  buffer_load_dwordx4 v28, s[20:23], s64 offen offset:2048  lds
  s_add_u32 m0, s50, 98304
  s_add_u32 s63, s63, 98304
  buffer_load_dwordx4 v23, s[16:19], s63 offen offset:0  lds
  buffer_load_dwordx4 v24, s[16:19], s63 offen offset:1024  lds
  buffer_load_dwordx4 v25, s[16:19], s63 offen offset:2048  lds
  s_add_u32 m0, s50, 110592
  s_add_u32 s63, s63, 98304
  buffer_load_dwordx4 v23, s[16:19], s63 offen offset:0  lds
  buffer_load_dwordx4 v24, s[16:19], s63 offen offset:1024  lds
  buffer_load_dwordx4 v25, s[16:19], s63 offen offset:2048  lds
  s_and_b32 s49, s73, 15
  s_cmp_lg_u32 s49, 3
  s_cbranch_scc1 L_T12_3
  s_bitcmp1_b32 s72, 0
  s_cselect_b32 s36, s8, s6
  s_cselect_b32 s37, s9, s7
  s_bfe_u32 s40, s73, 0x30004
  s_xor_b32 s40, s40, s33
  s_mul_i32 s40, s40, 384
  s_and_b32 s49, s72, 0xfe
  s_lshl_b32 s49, s49, 5
  s_lshr_b32 s72, s72, 8
  s_lshr_b32 s73, s73, 8
  s_or_b32 s73, s73, 0x0f000000
  v_add_u32 v34, s49, v14
  v_mul_u32_u24 v37, 43691, v34
  v_lshrrev_b32 v37, 17, v37
  v_mul_u32_u24 v37, 2688, v37
  v_lshl_add_u32 v34, v34, 7, v37
  buffer_load_dword v36, v34, s[36:39], s40 offen
L_T12_3:
  s_waitcnt vmcnt(6)
  s_barrier
  s_add_u32 m0, s50, 122880
  s_add_u32 s64, s64, 98304
  buffer_load_dwordx4 v26, s[20:23], s64 offen offset:0  lds
  buffer_load_dwordx4 v27, s[20:23], s64 offen offset:1024  lds
  buffer_load_dwordx4 v28, s[20:23], s64 offen offset:2048  lds
  s_add_u32 m0, s50, 135168
  s_add_u32 s64, s64, 98304
  buffer_load_dwordx4 v26, s[20:23], s64 offen offset:0  lds
  buffer_load_dwordx4 v27, s[20:23], s64 offen offset:1024  lds
  buffer_load_dwordx4 v28, s[20:23], s64 offen offset:2048  lds
  s_add_u32 m0, s50, 0
  s_add_u32 s63, s63, 98304
  buffer_load_dwordx4 v23, s[16:19], s63 offen offset:0  lds
  buffer_load_dwordx4 v24, s[16:19], s63 offen offset:1024  lds
  buffer_load_dwordx4 v25, s[16:19], s63 offen offset:2048  lds
  s_add_u32 m0, s50, 12288
  s_add_u32 s63, s63, 98304
  buffer_load_dwordx4 v23, s[16:19], s63 offen offset:0  lds
  buffer_load_dwordx4 v24, s[16:19], s63 offen offset:1024  lds
  buffer_load_dwordx4 v25, s[16:19], s63 offen offset:2048  lds
  s_waitcnt vmcnt(6)
  s_barrier
  s_add_u32 m0, s50, 24576
  s_add_u32 s64, s64, 98304
  buffer_load_dwordx4 v26, s[20:23], s64 offen offset:0  lds
  buffer_load_dwordx4 v27, s[20:23], s64 offen offset:1024  lds
  buffer_load_dwordx4 v28, s[20:23], s64 offen offset:2048  lds
  s_add_u32 m0, s50, 36864
  s_add_u32 s64, s64, 98304
  buffer_load_dwordx4 v26, s[20:23], s64 offen offset:0  lds
  buffer_load_dwordx4 v27, s[20:23], s64 offen offset:1024  lds
  buffer_load_dwordx4 v28, s[20:23], s64 offen offset:2048  lds
  s_waitcnt vmcnt(0)
  s_barrier
  s_add_u32 m0, s50, 73728
  s_add_u32 s64, s64, 98304
  buffer_load_dwordx4 v26, s[20:23], s64 offen offset:0  lds
  buffer_load_dwordx4 v27, s[20:23], s64 offen offset:1024  lds
  buffer_load_dwordx4 v28, s[20:23], s64 offen offset:2048  lds
  s_add_u32 m0, s50, 86016
  s_add_u32 s64, s64, 98304
  buffer_load_dwordx4 v26, s[20:23], s64 offen offset:0  lds
  buffer_load_dwordx4 v27, s[20:23], s64 offen offset:1024  lds
  buffer_load_dwordx4 v28, s[20:23], s64 offen offset:2048  lds
  s_waitcnt vmcnt(0)
  s_barrier
  s_endpgm
L_SH11:
  s_cbranch_execz RETH_R1
  s_add_u32 m0, s50, 36864
  s_add_u32 s63, s63, 98304
  buffer_load_dwordx4 v23, s[16:19], s63 offen offset:0  lds
  buffer_load_dwordx4 v24, s[16:19], s63 offen offset:1024  lds
  buffer_load_dwordx4 v25, s[16:19], s63 offen offset:2048  lds
  s_add_u32 m0, s50, 49152
  s_add_u32 s63, s63, 98304
  buffer_load_dwordx4 v23, s[16:19], s63 offen offset:0  lds
  buffer_load_dwordx4 v24, s[16:19], s63 offen offset:1024  lds
  buffer_load_dwordx4 v25, s[16:19], s63 offen offset:2048  lds
  s_add_u32 m0, s50, 61440
  s_add_u32 s63, s63, 98304
  buffer_load_dwordx4 v23, s[16:19], s63 offen offset:0  lds
  buffer_load_dwordx4 v24, s[16:19], s63 offen offset:1024  lds
  buffer_load_dwordx4 v25, s[16:19], s63 offen offset:2048  lds
  s_sub_u32 s49, s3, 26
  s_lshl2_add_u32 m0, s49, s32
  s_mov_b32 s38, 7369728
  s_mov_b32 s39, 0x20000
  s_mov_b32 s36, s6
  s_mov_b32 s37, s7
  s_mov_b32 s74, 0x1d
  s_mov_b32 s75, 0x3a
  s_mov_b32 s76, 0x65
  s_mov_b32 s77, 0x0
  s_mov_b32 s78, 0x57
  s_mov_b32 s79, 0x1f
  s_mov_b32 s80, 0x67
  s_mov_b32 s81, 0x0
  s_mov_b32 s82, 0x59
  s_mov_b32 s83, 0x21
  s_mov_b32 s84, 0xdb
  s_mov_b32 s85, 0x0
  s_movrels_b32 s72, s74
  s_mov_b32 s74, 0xf01
  s_mov_b32 s75, 0xf02
  s_mov_b32 s76, 0xf03
  s_mov_b32 s77, 0xf
  s_mov_b32 s78, 0xf01
  s_mov_b32 s79, 0xf02
  s_mov_b32 s80, 0xf03
  s_mov_b32 s81, 0xf
  s_mov_b32 s82, 0xf01
  s_mov_b32 s83, 0xf02
  s_mov_b32 s84, 0xf03
  s_mov_b32 s85, 0xf
  s_movrels_b32 s73, s74
  s_add_u32 m0, s50, 73728
  s_add_u32 s64, s64, 98304
  buffer_load_dwordx4 v26, s[20:23], s64 offen offset:0  lds
  buffer_load_dwordx4 v27, s[20:23], s64 offen offset:1024  lds
  buffer_load_dwordx4 v28, s[20:23], s64 offen offset:2048  lds
  s_add_u32 m0, s50, 86016
  s_add_u32 s64, s64, 98304
  buffer_load_dwordx4 v26, s[20:23], s64 offen offset:0  lds
  buffer_load_dwordx4 v27, s[20:23], s64 offen offset:1024  lds
  buffer_load_dwordx4 v28, s[20:23], s64 offen offset:2048  lds
  s_waitcnt vmcnt(12)
  s_barrier
  s_setprio 1
  buffer_load_dword v36, v38, s[24:27], s68 offen
  s_add_u32 m0, s50, 98304
  s_add_u32 s63, s63, 98304
  buffer_load_dwordx4 v23, s[16:19], s63 offen offset:0  lds
  buffer_load_dwordx4 v24, s[16:19], s63 offen offset:1024  lds
  buffer_load_dwordx4 v25, s[16:19], s63 offen offset:2048  lds
  s_add_u32 m0, s50, 110592
  s_add_u32 s63, s63, 98304
  buffer_load_dwordx4 v23, s[16:19], s63 offen offset:0  lds
  buffer_load_dwordx4 v24, s[16:19], s63 offen offset:1024  lds
  buffer_load_dwordx4 v25, s[16:19], s63 offen offset:2048  lds
  s_waitcnt vmcnt(7)
  s_barrier
  s_add_u32 m0, s50, 122880
  s_add_u32 s64, s64, 98304
  buffer_load_dwordx4 v26, s[20:23], s64 offen offset:0  lds
  buffer_load_dwordx4 v27, s[20:23], s64 offen offset:1024  lds
  buffer_load_dwordx4 v28, s[20:23], s64 offen offset:2048  lds
  s_add_u32 m0, s50, 135168
  s_add_u32 s64, s64, 98304
  buffer_load_dwordx4 v26, s[20:23], s64 offen offset:0  lds
  buffer_load_dwordx4 v27, s[20:23], s64 offen offset:1024  lds
  buffer_load_dwordx4 v28, s[20:23], s64 offen offset:2048  lds
  s_add_u32 m0, s50, 0
  s_add_u32 s63, s63, 98304
  buffer_load_dwordx4 v23, s[16:19], s63 offen offset:0  lds
  buffer_load_dwordx4 v24, s[16:19], s63 offen offset:1024  lds
  buffer_load_dwordx4 v25, s[16:19], s63 offen offset:2048  lds
  s_add_u32 m0, s50, 12288
  s_add_u32 s63, s63, 98304
  buffer_load_dwordx4 v23, s[16:19], s63 offen offset:0  lds
  buffer_load_dwordx4 v24, s[16:19], s63 offen offset:1024  lds
  buffer_load_dwordx4 v25, s[16:19], s63 offen offset:2048  lds
  s_and_b32 s49, s73, 15
  s_cmp_lg_u32 s49, 1
  s_cbranch_scc1 L_T11_1
  s_bitcmp1_b32 s72, 0
  s_cselect_b32 s36, s8, s6
  s_cselect_b32 s37, s9, s7
  s_bfe_u32 s40, s73, 0x30004
  s_xor_b32 s40, s40, s33
  s_mul_i32 s40, s40, 384
  s_and_b32 s49, s72, 0xfe
  s_lshl_b32 s49, s49, 5
  s_lshr_b32 s72, s72, 8
  s_lshr_b32 s73, s73, 8
  s_or_b32 s73, s73, 0x0f000000
  v_add_u32 v34, s49, v14
  v_mul_u32_u24 v37, 43691, v34
  v_lshrrev_b32 v37, 17, v37
  v_mul_u32_u24 v37, 2688, v37
  v_lshl_add_u32 v34, v34, 7, v37
  buffer_load_dword v36, v34, s[36:39], s40 offen
L_T11_1:
  s_waitcnt vmcnt(6)
  s_barrier
  s_add_u32 m0, s50, 24576
  s_add_u32 s64, s64, 98304
  buffer_load_dwordx4 v26, s[20:23], s64 offen offset:0  lds
  buffer_load_dwordx4 v27, s[20:23], s64 offen offset:1024  lds
  buffer_load_dwordx4 v28, s[20:23], s64 offen offset:2048  lds
  s_add_u32 m0, s50, 36864
  s_add_u32 s64, s64, 98304
  buffer_load_dwordx4 v26, s[20:23], s64 offen offset:0  lds
  buffer_load_dwordx4 v27, s[20:23], s64 offen offset:1024  lds
  buffer_load_dwordx4 v28, s[20:23], s64 offen offset:2048  lds
  s_add_u32 m0, s50, 49152
  s_add_u32 s63, s63, 98304
  buffer_load_dwordx4 v23, s[16:19], s63 offen offset:0  lds
  buffer_load_dwordx4 v24, s[16:19], s63 offen offset:1024  lds
  buffer_load_dwordx4 v25, s[16:19], s63 offen offset:2048  lds
  s_add_u32 m0, s50, 61440
  s_add_u32 s63, s63, 98304
  buffer_load_dwordx4 v23, s[16:19], s63 offen offset:0  lds
  buffer_load_dwordx4 v24, s[16:19], s63 offen offset:1024  lds
  buffer_load_dwordx4 v25, s[16:19], s63 offen offset:2048  lds
  s_and_b32 s49, s73, 15
  s_cmp_lg_u32 s49, 2
  s_cbranch_scc1 L_T11_2
  s_bitcmp1_b32 s72, 0
  s_cselect_b32 s36, s8, s6
  s_cselect_b32 s37, s9, s7
  s_bfe_u32 s40, s73, 0x30004
  s_xor_b32 s40, s40, s33
  s_mul_i32 s40, s40, 384
  s_and_b32 s49, s72, 0xfe
  s_lshl_b32 s49, s49, 5
  s_lshr_b32 s72, s72, 8
  s_lshr_b32 s73, s73, 8
  s_or_b32 s73, s73, 0x0f000000
  v_add_u32 v34, s49, v14
  v_mul_u32_u24 v37, 43691, v34
  v_lshrrev_b32 v37, 17, v37
  v_mul_u32_u24 v37, 2688, v37
  v_lshl_add_u32 v34, v34, 7, v37
  buffer_load_dword v36, v34, s[36:39], s40 offen
L_T11_2:
  s_waitcnt vmcnt(6)
  s_barrier
  s_add_u32 m0, s50, 73728
  s_add_u32 s64, s64, 98304
  buffer_load_dwordx4 v26, s[20:23], s64 offen offset:0  lds
  buffer_load_dwordx4 v27, s[20:23], s64 offen offset:1024  lds
  buffer_load_dwordx4 v28, s[20:23], s64 offen offset:2048  lds
  s_add_u32 m0, s50, 86016
  s_add_u32 s64, s64, 98304
  buffer_load_dwordx4 v26, s[20:23], s64 offen offset:0  lds
  buffer_load_dwordx4 v27, s[20:23], s64 offen offset:1024  lds
  buffer_load_dwordx4 v28, s[20:23], s64 offen offset:2048  lds
  s_add_u32 m0, s50, 98304
  s_add_u32 s63, s63, 98304
  buffer_load_dwordx4 v23, s[16:19], s63 offen offset:0  lds
  buffer_load_dwordx4 v24, s[16:19], s63 offen offset:1024  lds
  buffer_load_dwordx4 v25, s[16:19], s63 offen offset:2048  lds
  s_add_u32 m0, s50, 110592
  s_add_u32 s63, s63, 98304
  buffer_load_dwordx4 v23, s[16:19], s63 offen offset:0  lds
  buffer_load_dwordx4 v24, s[16:19], s63 offen offset:1024  lds
  buffer_load_dwordx4 v25, s[16:19], s63 offen offset:2048  lds
  s_and_b32 s49, s73, 15
  s_cmp_lg_u32 s49, 3
  s_cbranch_scc1 L_T11_3
  s_bitcmp1_b32 s72, 0
  s_cselect_b32 s36, s8, s6
  s_cselect_b32 s37, s9, s7
  s_bfe_u32 s40, s73, 0x30004
  s_xor_b32 s40, s40, s33
  s_mul_i32 s40, s40, 384
  s_and_b32 s49, s72, 0xfe
  s_lshl_b32 s49, s49, 5
  s_lshr_b32 s72, s72, 8
  s_lshr_b32 s73, s73, 8
  s_or_b32 s73, s73, 0x0f000000
  v_add_u32 v34, s49, v14
  v_mul_u32_u24 v37, 43691, v34
  v_lshrrev_b32 v37, 17, v37
  v_mul_u32_u24 v37, 2688, v37
  v_lshl_add_u32 v34, v34, 7, v37
  buffer_load_dword v36, v34, s[36:39], s40 offen
L_T11_3:
  s_waitcnt vmcnt(6)
  s_barrier
  s_add_u32 m0, s50, 122880
  s_add_u32 s64, s64, 98304
  buffer_load_dwordx4 v26, s[20:23], s64 offen offset:0  lds
  buffer_load_dwordx4 v27, s[20:23], s64 offen offset:1024  lds
  buffer_load_dwordx4 v28, s[20:23], s64 offen offset:2048  lds
  s_add_u32 m0, s50, 135168
  s_add_u32 s64, s64, 98304
  buffer_load_dwordx4 v26, s[20:23], s64 offen offset:0  lds
  buffer_load_dwordx4 v27, s[20:23], s64 offen offset:1024  lds
  buffer_load_dwordx4 v28, s[20:23], s64 offen offset:2048  lds
  s_add_u32 m0, s50, 0
  s_add_u32 s63, s63, 98304
  buffer_load_dwordx4 v23, s[16:19], s63 offen offset:0  lds
  buffer_load_dwordx4 v24, s[16:19], s63 offen offset:1024  lds
  buffer_load_dwordx4 v25, s[16:19], s63 offen offset:2048  lds
  s_waitcnt vmcnt(3)
  s_barrier
  s_add_u32 m0, s50, 24576
  s_add_u32 s64, s64, 98304
  buffer_load_dwordx4 v26, s[20:23], s64 offen offset:0  lds
  buffer_load_dwordx4 v27, s[20:23], s64 offen offset:1024  lds
  buffer_load_dwordx4 v28, s[20:23], s64 offen offset:2048  lds
  s_add_u32 m0, s50, 36864
  s_add_u32 s64, s64, 98304
  buffer_load_dwordx4 v26, s[20:23], s64 offen offset:0  lds
  buffer_load_dwordx4 v27, s[20:23], s64 offen offset:1024  lds
  buffer_load_dwordx4 v28, s[20:23], s64 offen offset:2048  lds
  s_waitcnt vmcnt(0)
  s_barrier
  s_add_u32 m0, s50, 73728
  s_add_u32 s64, s64, 98304
  buffer_load_dwordx4 v26, s[20:23], s64 offen offset:0  lds
  buffer_load_dwordx4 v27, s[20:23], s64 offen offset:1024  lds
  buffer_load_dwordx4 v28, s[20:23], s64 offen offset:2048  lds
  s_waitcnt vmcnt(0)
  s_barrier
  s_endpgm
.p2align 12
L_SH5:
  s_cbranch_execz RETH_R1
  s_add_u32 m0, s50, 24576
  s_sub_u32 s67, s55, 196608
  s_sub_u32 s62, s62, 196608
  buffer_load_dwordx4 v20, s[24:27], s67 offen offset:0 nt lds
  buffer_load_dwordx4 v21, s[24:27], s67 offen offset:1024 nt lds
  buffer_load_dwordx4 v22, s[24:27], s67 offen offset:2048 nt lds
  s_add_u32 m0, s50, 36864
  s_add_u32 s51, s67, 384
  buffer_load_dwordx4 v20, s[24:27], s51 offen offset:0 nt lds
  buffer_load_dwordx4 v21, s[24:27], s51 offen offset:1024 nt lds
  buffer_load_dwordx4 v22, s[24:27], s51 offen offset:2048 nt lds
  s_add_u32 m0, s50, 73728
  s_add_u32 s63, s63, 98304
  buffer_load_dwordx4 v23, s[16:19], s63 offen offset:0  lds
  buffer_load_dwordx4 v24, s[16:19], s63 offen offset:1024  lds
  buffer_load_dwordx4 v25, s[16:19], s63 offen offset:2048  lds
  s_add_u32 m0, s50, 86016
  s_add_u32 s64, s64, 98304
  buffer_load_dwordx4 v26, s[20:23], s64 offen offset:0  lds
  buffer_load_dwordx4 v27, s[20:23], s64 offen offset:1024  lds
  buffer_load_dwordx4 v28, s[20:23], s64 offen offset:2048  lds
  s_waitcnt vmcnt(12)
  s_barrier
  s_setprio 1
  s_add_u32 m0, s50, 98304
  s_add_u32 s63, s63, 98304
  buffer_load_dwordx4 v23, s[16:19], s63 offen offset:0  lds
  buffer_load_dwordx4 v24, s[16:19], s63 offen offset:1024  lds
  buffer_load_dwordx4 v25, s[16:19], s63 offen offset:2048  lds
  s_add_u32 m0, s50, 110592
  s_add_u32 s64, s64, 98304
  buffer_load_dwordx4 v26, s[20:23], s64 offen offset:0  lds
  buffer_load_dwordx4 v27, s[20:23], s64 offen offset:1024  lds
  buffer_load_dwordx4 v28, s[20:23], s64 offen offset:2048  lds
  s_waitcnt vmcnt(6)
  s_barrier
  s_add_u32 m0, s50, 122880
  s_add_u32 s63, s63, 98304
  buffer_load_dwordx4 v23, s[16:19], s63 offen offset:0  lds
  buffer_load_dwordx4 v24, s[16:19], s63 offen offset:1024  lds
  buffer_load_dwordx4 v25, s[16:19], s63 offen offset:2048  lds
  s_add_u32 m0, s50, 135168
  s_add_u32 s64, s64, 98304
  buffer_load_dwordx4 v26, s[20:23], s64 offen offset:0  lds
  buffer_load_dwordx4 v27, s[20:23], s64 offen offset:1024  lds
  buffer_load_dwordx4 v28, s[20:23], s64 offen offset:2048  lds
  s_add_u32 m0, s50, 0
  s_mov_b32 s18, s71
  s_mov_b32 s63, s70
  buffer_load_dwordx4 v23, s[16:19], s63 offen offset:0  lds
  buffer_load_dwordx4 v24, s[16:19], s63 offen offset:1024  lds
  buffer_load_dwordx4 v25, s[16:19], s63 offen offset:2048  lds
  s_add_u32 m0, s50, 12288
  s_add_u32 s64, s64, 98304
  buffer_load_dwordx4 v26, s[20:23], s64 offen offset:0  lds
  buffer_load_dwordx4 v27, s[20:23], s64 offen offset:1024  lds
  buffer_load_dwordx4 v28, s[20:23], s64 offen offset:2048  lds
  s_waitcnt vmcnt(12)
  s_barrier
  s_add_u32 m0, s50, 24576
  s_mov_b32 s26, s69
  s_mov_b32 s67, s68
  buffer_load_dwordx4 v20, s[24:27], s67 offen offset:0 nt lds
  buffer_load_dwordx4 v21, s[24:27], s67 offen offset:1024 nt lds
  buffer_load_dwordx4 v22, s[24:27], s67 offen offset:2048 nt lds
  s_add_u32 m0, s50, 36864
  s_add_u32 s51, s67, 384
  buffer_load_dwordx4 v20, s[24:27], s51 offen offset:0 nt lds
  buffer_load_dwordx4 v21, s[24:27], s51 offen offset:1024 nt lds
  buffer_load_dwordx4 v22, s[24:27], s51 offen offset:2048 nt lds
  s_add_u32 m0, s50, 49152
  s_add_u32 s67, s67, 196608
  buffer_load_dwordx4 v20, s[24:27], s67 offen offset:0 nt lds
  buffer_load_dwordx4 v21, s[24:27], s67 offen offset:1024 nt lds
  buffer_load_dwordx4 v22, s[24:27], s67 offen offset:2048 nt lds
  s_add_u32 m0, s50, 61440
  s_add_u32 s51, s67, 384
  buffer_load_dwordx4 v20, s[24:27], s51 offen offset:0 nt lds
  buffer_load_dwordx4 v21, s[24:27], s51 offen offset:1024 nt lds
  buffer_load_dwordx4 v22, s[24:27], s51 offen offset:2048 nt lds
  s_waitcnt vmcnt(18)
  s_barrier
  s_waitcnt vmcnt(0)
  s_barrier
  s_add_u32 m0, s50, 73728
  s_add_u32 s63, s63, 98304
  buffer_load_dwordx4 v23, s[16:19], s63 offen offset:0  lds
  buffer_load_dwordx4 v24, s[16:19], s63 offen offset:1024  lds
  buffer_load_dwordx4 v25, s[16:19], s63 offen offset:2048  lds
  s_add_u32 m0, s50, 86016
  s_mov_b32 s22, s71
  s_mov_b32 s64, s70
  buffer_load_dwordx4 v26, s[20:23], s64 offen offset:0  lds
  buffer_load_dwordx4 v27, s[20:23], s64 offen offset:1024  lds
  buffer_load_dwordx4 v28, s[20:23], s64 offen offset:2048  lds
  s_waitcnt vmcnt(0)
  s_barrier
  v_add_u32 v32, 24576, v29
  v_add_u32 v33, 49152, v29
  ds_read_b128 v[64:67], v32 offset:0
  ds_read_b128 v[80:83], v32 offset:128
  ds_read_b128 v[96:99], v32 offset:256
  ds_read_b128 v[68:71], v32 offset:12288
  ds_read_b128 v[84:87], v32 offset:12416
  ds_read_b128 v[100:103], v32 offset:12544
  ds_read_b128 v[72:75], v33 offset:0
  ds_read_b128 v[88:91], v33 offset:128
  ds_read_b128 v[104:107], v33 offset:256
  ds_read_b128 v[76:79], v33 offset:12288
  ds_read_b128 v[92:95], v33 offset:12416
  ds_read_b128 v[108:111], v33 offset:12544
  s_waitcnt lgkmcnt(0)
  s_add_u32 m0, s50, 98304
  s_add_u32 s63, s63, 98304
  buffer_load_dwordx4 v23, s[16:19], s63 offen offset:0  lds
  buffer_load_dwordx4 v24, s[16:19], s63 offen offset:1024  lds
  buffer_load_dwordx4 v25, s[16:19], s63 offen offset:2048  lds
  s_add_u32 m0, s50, 110592
  s_add_u32 s64, s64, 98304
  buffer_load_dwordx4 v26, s[20:23], s64 offen offset:0  lds
  buffer_load_dwordx4 v27, s[20:23], s64 offen offset:1024  lds
  buffer_load_dwordx4 v28, s[20:23], s64 offen offset:2048  lds
  s_add_u32 m0, s50, 122880
  s_add_u32 s63, s63, 98304
  buffer_load_dwordx4 v23, s[16:19], s63 offen offset:0  lds
  buffer_load_dwordx4 v24, s[16:19], s63 offen offset:1024  lds
  buffer_load_dwordx4 v25, s[16:19], s63 offen offset:2048  lds
  s_add_u32 m0, s50, 135168
  s_add_u32 s64, s64, 98304
  buffer_load_dwordx4 v26, s[20:23], s64 offen offset:0  lds
  buffer_load_dwordx4 v27, s[20:23], s64 offen offset:1024  lds
  buffer_load_dwordx4 v28, s[20:23], s64 offen offset:2048  lds
  s_waitcnt vmcnt(6)
  s_barrier
  s_add_u32 m0, s50, 0
  s_add_u32 s63, s63, 98304
  buffer_load_dwordx4 v23, s[16:19], s63 offen offset:0  lds
  buffer_load_dwordx4 v24, s[16:19], s63 offen offset:1024  lds
  buffer_load_dwordx4 v25, s[16:19], s63 offen offset:2048  lds
  s_add_u32 m0, s50, 12288
  s_add_u32 s64, s64, 98304
  buffer_load_dwordx4 v26, s[20:23], s64 offen offset:0  lds
  buffer_load_dwordx4 v27, s[20:23], s64 offen offset:1024  lds
  buffer_load_dwordx4 v28, s[20:23], s64 offen offset:2048  lds
  s_waitcnt vmcnt(6)
  s_barrier
  s_add_u32 m0, s50, 36864
  s_add_u32 s64, s64, 98304
  buffer_load_dwordx4 v26, s[20:23], s64 offen offset:0  lds
  buffer_load_dwordx4 v27, s[20:23], s64 offen offset:1024  lds
  buffer_load_dwordx4 v28, s[20:23], s64 offen offset:2048  lds
  buffer_store_dwordx4 v[64:67], v30, s[28:31], s62 offen offset:0 sc0 sc1 nt
  buffer_store_dwordx4 v[80:83], v30, s[28:31], s62 offen offset:128 sc0 sc1 nt
  buffer_store_dwordx4 v[96:99], v30, s[28:31], s62 offen offset:256 sc0 sc1 nt
  buffer_store_dwordx4 v[68:71], v30, s[28:31], s62 offen offset:384 sc0 sc1 nt
  s_waitcnt vmcnt(7)
  s_barrier
  buffer_store_dwordx4 v[84:87], v30, s[28:31], s62 offen offset:512 sc0 sc1 nt
  buffer_store_dwordx4 v[100:103], v30, s[28:31], s62 offen offset:640 sc0 sc1 nt
  s_add_u32 s62, s62, 196608
  buffer_store_dwordx4 v[72:75], v30, s[28:31], s62 offen offset:0 sc0 sc1 nt
  buffer_store_dwordx4 v[88:91], v30, s[28:31], s62 offen offset:128 sc0 sc1 nt
  s_waitcnt vmcnt(8)
  s_barrier
  buffer_store_dwordx4 v[104:107], v30, s[28:31], s62 offen offset:256 sc0 sc1 nt
  buffer_store_dwordx4 v[76:79], v30, s[28:31], s62 offen offset:384 sc0 sc1 nt
  buffer_store_dwordx4 v[92:95], v30, s[28:31], s62 offen offset:512 sc0 sc1 nt
  buffer_store_dwordx4 v[108:111], v30, s[28:31], s62 offen offset:640 sc0 sc1 nt
  s_endpgm
L_SH0:
  s_cbranch_execz RETH_R1
  s_add_u32 m0, s50, 24576
  s_sub_u32 s67, s55, 196608
  s_sub_u32 s62, s62, 196608
  buffer_load_dwordx4 v20, s[24:27], s67 offen offset:0 nt lds
  buffer_load_dwordx4 v21, s[24:27], s67 offen offset:1024 nt lds
  buffer_load_dwordx4 v22, s[24:27], s67 offen offset:2048 nt lds
  s_add_u32 m0, s50, 36864
  s_add_u32 s51, s67, 384
  buffer_load_dwordx4 v20, s[24:27], s51 offen offset:0 nt lds
  buffer_load_dwordx4 v21, s[24:27], s51 offen offset:1024 nt lds
  buffer_load_dwordx4 v22, s[24:27], s51 offen offset:2048 nt lds
  s_add_u32 m0, s50, 73728
  s_add_u32 s63, s63, 98304
  buffer_load_dwordx4 v23, s[16:19], s63 offen offset:0  lds
  buffer_load_dwordx4 v24, s[16:19], s63 offen offset:1024  lds
  buffer_load_dwordx4 v25, s[16:19], s63 offen offset:2048  lds
  s_add_u32 m0, s50, 86016
  s_add_u32 s64, s64, 98304
  buffer_load_dwordx4 v26, s[20:23], s64 offen offset:0  lds
  buffer_load_dwordx4 v27, s[20:23], s64 offen offset:1024  lds
  buffer_load_dwordx4 v28, s[20:23], s64 offen offset:2048  lds
  s_waitcnt vmcnt(12)
  s_barrier
  s_setprio 1
  s_add_u32 m0, s50, 98304
  s_add_u32 s63, s63, 98304
  buffer_load_dwordx4 v23, s[16:19], s63 offen offset:0  lds
  buffer_load_dwordx4 v24, s[16:19], s63 offen offset:1024  lds
  buffer_load_dwordx4 v25, s[16:19], s63 offen offset:2048  lds
  s_add_u32 m0, s50, 110592
  s_add_u32 s64, s64, 98304
  buffer_load_dwordx4 v26, s[20:23], s64 offen offset:0  lds
  buffer_load_dwordx4 v27, s[20:23], s64 offen offset:1024  lds
  buffer_load_dwordx4 v28, s[20:23], s64 offen offset:2048  lds
  s_add_u32 m0, s50, 122880
  s_mov_b32 s26, s69
  s_mov_b32 s67, s68
  buffer_load_dwordx4 v20, s[24:27], s67 offen offset:0 nt lds
  buffer_load_dwordx4 v21, s[24:27], s67 offen offset:1024 nt lds
  buffer_load_dwordx4 v22, s[24:27], s67 offen offset:2048 nt lds
  s_add_u32 m0, s50, 135168
  s_add_u32 s51, s67, 384
  buffer_load_dwordx4 v20, s[24:27], s51 offen offset:0 nt lds
  buffer_load_dwordx4 v21, s[24:27], s51 offen offset:1024 nt lds
  buffer_load_dwordx4 v22, s[24:27], s51 offen offset:2048 nt lds
  s_waitcnt vmcnt(12)
  s_barrier
  s_add_u32 m0, s50, 0
  s_add_u32 s67, s67, 196608
  buffer_load_dwordx4 v20, s[24:27], s67 offen offset:0 nt lds
  buffer_load_dwordx4 v21, s[24:27], s67 offen offset:1024 nt lds
  buffer_load_dwordx4 v22, s[24:27], s67 offen offset:2048 nt lds
  s_add_u32 m0, s50, 12288
  s_add_u32 s51, s67, 384
  buffer_load_dwordx4 v20, s[24:27], s51 offen offset:0 nt lds
  buffer_load_dwordx4 v21, s[24:27], s51 offen offset:1024 nt lds
  buffer_load_dwordx4 v22, s[24:27], s51 offen offset:2048 nt lds
  s_waitcnt vmcnt(0)
  s_barrier
  s_waitcnt vmcnt(0)
  s_barrier
  v_add_u32 v32, 122880, v29
  v_add_u32 v33, 0, v29
  ds_read_b128 v[64:67], v32 offset:0
  ds_read_b128 v[80:83], v32 offset:128
  ds_read_b128 v[96:99], v32 offset:256
  ds_read_b128 v[68:71], v32 offset:12288
  ds_read_b128 v[84:87], v32 offset:12416
  ds_read_b128 v[100:103], v32 offset:12544
  ds_read_b128 v[72:75], v33 offset:0
  ds_read_b128 v[88:91], v33 offset:128
  ds_read_b128 v[104:107], v33 offset:256
  ds_read_b128 v[76:79], v33 offset:12288
  ds_read_b128 v[92:95], v33 offset:12416
  ds_read_b128 v[108:111], v33 offset:12544
  s_waitcnt lgkmcnt(0)
  s_add_u32 m0, s50, 122880
  s_add_u32 s63, s63, 98304
  buffer_load_dwordx4 v23, s[16:19], s63 offen offset:0  lds
  buffer_load_dwordx4 v24, s[16:19], s63 offen offset:1024  lds
  buffer_load_dwordx4 v25, s[16:19], s63 offen offset:2048  lds
  s_add_u32 m0, s50, 135168
  s_add_u32 s64, s64, 98304
  buffer_load_dwordx4 v26, s[20:23], s64 offen offset:0  lds
  buffer_load_dwordx4 v27, s[20:23], s64 offen offset:1024  lds
  buffer_load_dwordx4 v28, s[20:23], s64 offen offset:2048  lds
  s_waitcnt vmcnt(6)
  s_barrier
  s_add_u32 m0, s50, 0
  s_add_u32 s63, s63, 98304
  buffer_load_dwordx4 v23, s[16:19], s63 offen offset:0  lds
  buffer_load_dwordx4 v24, s[16:19], s63 offen offset:1024  lds
  buffer_load_dwordx4 v25, s[16:19], s63 offen offset:2048  lds
  s_add_u32 m0, s50, 12288
  s_add_u32 s64, s64, 98304
  buffer_load_dwordx4 v26, s[20:23], s64 offen offset:0  lds
  buffer_load_dwordx4 v27, s[20:23], s64 offen offset:1024  lds
  buffer_load_dwordx4 v28, s[20:23], s64 offen offset:2048  lds
  s_waitcnt vmcnt(6)
  s_barrier
  s_add_u32 m0, s50, 24576
  s_add_u32 s63, s63, 98304
  buffer_load_dwordx4 v23, s[16:19], s63 offen offset:0  lds
  buffer_load_dwordx4 v24, s[16:19], s63 offen offset:1024  lds
  buffer_load_dwordx4 v25, s[16:19], s63 offen offset:2048  lds
  s_add_u32 m0, s50, 36864
  s_add_u32 s64, s64, 98304
  buffer_load_dwordx4 v26, s[20:23], s64 offen offset:0  lds
  buffer_load_dwordx4 v27, s[20:23], s64 offen offset:1024  lds
  buffer_load_dwordx4 v28, s[20:23], s64 offen offset:2048  lds
  buffer_store_dwordx4 v[64:67], v30, s[28:31], s62 offen offset:0 sc0 sc1 nt
  buffer_store_dwordx4 v[80:83], v30, s[28:31], s62 offen offset:128 sc0 sc1 nt
  s_waitcnt vmcnt(8)
  s_barrier
  s_add_u32 m0, s50, 49152
  s_add_u32 s63, s63, 98304
  buffer_load_dwordx4 v23, s[16:19], s63 offen offset:0  lds
  buffer_load_dwordx4 v24, s[16:19], s63 offen offset:1024  lds
  buffer_load_dwordx4 v25, s[16:19], s63 offen offset:2048  lds
  s_add_u32 m0, s50, 61440
  s_add_u32 s64, s64, 98304
  buffer_load_dwordx4 v26, s[20:23], s64 offen offset:0  lds
  buffer_load_dwordx4 v27, s[20:23], s64 offen offset:1024  lds
  buffer_load_dwordx4 v28, s[20:23], s64 offen offset:2048  lds
  buffer_store_dwordx4 v[96:99], v30, s[28:31], s62 offen offset:256 sc0 sc1 nt
  buffer_store_dwordx4 v[68:71], v30, s[28:31], s62 offen offset:384 sc0 sc1 nt
  s_waitcnt vmcnt(10)
  s_barrier
  s_add_u32 m0, s50, 73728
  s_add_u32 s63, s63, 98304
  buffer_load_dwordx4 v23, s[16:19], s63 offen offset:0  lds
  buffer_load_dwordx4 v24, s[16:19], s63 offen offset:1024  lds
  buffer_load_dwordx4 v25, s[16:19], s63 offen offset:2048  lds
  s_add_u32 m0, s50, 86016
  s_add_u32 s64, s64, 98304
  buffer_load_dwordx4 v26, s[20:23], s64 offen offset:0  lds
  buffer_load_dwordx4 v27, s[20:23], s64 offen offset:1024  lds
  buffer_load_dwordx4 v28, s[20:23], s64 offen offset:2048  lds
  buffer_store_dwordx4 v[84:87], v30, s[28:31], s62 offen offset:512 sc0 sc1 nt
  buffer_store_dwordx4 v[100:103], v30, s[28:31], s62 offen offset:640 sc0 sc1 nt
  s_waitcnt vmcnt(10)
  s_barrier
  s_add_u32 m0, s50, 110592
  s_add_u32 s64, s64, 98304
  buffer_load_dwordx4 v26, s[20:23], s64 offen offset:0  lds
  buffer_load_dwordx4 v27, s[20:23], s64 offen offset:1024  lds
  buffer_load_dwordx4 v28, s[20:23], s64 offen offset:2048  lds
  s_add_u32 s62, s62, 196608
  buffer_store_dwordx4 v[72:75], v30, s[28:31], s62 offen offset:0 sc0 sc1 nt
  buffer_store_dwordx4 v[88:91], v30, s[28:31], s62 offen offset:128 sc0 sc1 nt
  s_waitcnt vmcnt(7)
  s_barrier
  buffer_store_dwordx4 v[104:107], v30, s[28:31], s62 offen offset:256 sc0 sc1 nt
  buffer_store_dwordx4 v[76:79], v30, s[28:31], s62 offen offset:384 sc0 sc1 nt
  s_waitcnt vmcnt(4)
  s_barrier
  buffer_store_dwordx4 v[92:95], v30, s[28:31], s62 offen offset:512 sc0 sc1 nt
  buffer_store_dwordx4 v[108:111], v30, s[28:31], s62 offen offset:640 sc0 sc1 nt
  s_endpgm
L_SH4:
  s_cbranch_execz RETH_R1
  s_add_u32 m0, s50, 24576
  s_sub_u32 s67, s55, 196608
  s_sub_u32 s62, s62, 196608
  buffer_load_dwordx4 v20, s[24:27], s67 offen offset:0 nt lds
  buffer_load_dwordx4 v21, s[24:27], s67 offen offset:1024 nt lds
  buffer_load_dwordx4 v22, s[24:27], s67 offen offset:2048 nt lds
  s_add_u32 m0, s50, 36864
  s_add_u32 s51, s67, 384
  buffer_load_dwordx4 v20, s[24:27], s51 offen offset:0 nt lds
  buffer_load_dwordx4 v21, s[24:27], s51 offen offset:1024 nt lds
  buffer_load_dwordx4 v22, s[24:27], s51 offen offset:2048 nt lds
  s_add_u32 m0, s50, 73728
  s_add_u32 s63, s63, 98304
  buffer_load_dwordx4 v23, s[16:19], s63 offen offset:0  lds
  buffer_load_dwordx4 v24, s[16:19], s63 offen offset:1024  lds
  buffer_load_dwordx4 v25, s[16:19], s63 offen offset:2048  lds
  s_add_u32 m0, s50, 86016
  s_add_u32 s64, s64, 98304
  buffer_load_dwordx4 v26, s[20:23], s64 offen offset:0  lds
  buffer_load_dwordx4 v27, s[20:23], s64 offen offset:1024  lds
  buffer_load_dwordx4 v28, s[20:23], s64 offen offset:2048  lds
  s_waitcnt vmcnt(12)
  s_barrier
  s_setprio 1
  s_add_u32 m0, s50, 98304
  s_add_u32 s63, s63, 98304
  buffer_load_dwordx4 v23, s[16:19], s63 offen offset:0  lds
  buffer_load_dwordx4 v24, s[16:19], s63 offen offset:1024  lds
  buffer_load_dwordx4 v25, s[16:19], s63 offen offset:2048  lds
  s_add_u32 m0, s50, 110592
  s_add_u32 s64, s64, 98304
  buffer_load_dwordx4 v26, s[20:23], s64 offen offset:0  lds
  buffer_load_dwordx4 v27, s[20:23], s64 offen offset:1024  lds
  buffer_load_dwordx4 v28, s[20:23], s64 offen offset:2048  lds
  s_waitcnt vmcnt(6)
  s_barrier
  s_add_u32 m0, s50, 122880
  s_mov_b32 s18, s71
  s_mov_b32 s63, s70
  buffer_load_dwordx4 v23, s[16:19], s63 offen offset:0  lds
  buffer_load_dwordx4 v24, s[16:19], s63 offen offset:1024  lds
  buffer_load_dwordx4 v25, s[16:19], s63 offen offset:2048  lds
  s_add_u32 m0, s50, 135168
  s_add_u32 s64, s64, 98304
  buffer_load_dwordx4 v26, s[20:23], s64 offen offset:0  lds
  buffer_load_dwordx4 v27, s[20:23], s64 offen offset:1024  lds
  buffer_load_dwordx4 v28, s[20:23], s64 offen offset:2048  lds
  s_add_u32 m0, s50, 0
  s_mov_b32 s26, s69
  s_mov_b32 s67, s68
  buffer_load_dwordx4 v20, s[24:27], s67 offen offset:0 nt lds
  buffer_load_dwordx4 v21, s[24:27], s67 offen offset:1024 nt lds
  buffer_load_dwordx4 v22, s[24:27], s67 offen offset:2048 nt lds
  s_add_u32 m0, s50, 12288
  s_add_u32 s51, s67, 384
  buffer_load_dwordx4 v20, s[24:27], s51 offen offset:0 nt lds
  buffer_load_dwordx4 v21, s[24:27], s51 offen offset:1024 nt lds
  buffer_load_dwordx4 v22, s[24:27], s51 offen offset:2048 nt lds
  s_waitcnt vmcnt(12)
  s_barrier
  s_add_u32 m0, s50, 24576
  s_add_u32 s67, s67, 196608
  buffer_load_dwordx4 v20, s[24:27], s67 offen offset:0 nt lds
  buffer_load_dwordx4 v21, s[24:27], s67 offen offset:1024 nt lds
  buffer_load_dwordx4 v22, s[24:27], s67 offen offset:2048 nt lds
  s_add_u32 m0, s50, 36864
  s_add_u32 s51, s67, 384
  buffer_load_dwordx4 v20, s[24:27], s51 offen offset:0 nt lds
  buffer_load_dwordx4 v21, s[24:27], s51 offen offset:1024 nt lds
  buffer_load_dwordx4 v22, s[24:27], s51 offen offset:2048 nt lds
  s_add_u32 m0, s50, 49152
  s_add_u32 s63, s63, 98304
  buffer_load_dwordx4 v23, s[16:19], s63 offen offset:0  lds
  buffer_load_dwordx4 v24, s[16:19], s63 offen offset:1024  lds
  buffer_load_dwordx4 v25, s[16:19], s63 offen offset:2048  lds
  s_add_u32 m0, s50, 61440
  s_mov_b32 s22, s71
  s_mov_b32 s64, s70
  buffer_load_dwordx4 v26, s[20:23], s64 offen offset:0  lds
  buffer_load_dwordx4 v27, s[20:23], s64 offen offset:1024  lds
  buffer_load_dwordx4 v28, s[20:23], s64 offen offset:2048  lds
  s_waitcnt vmcnt(6)
  s_barrier
  s_waitcnt vmcnt(0)
  s_barrier
  v_add_u32 v32, 0, v29
  v_add_u32 v33, 24576, v29
  ds_read_b128 v[64:67], v32 offset:0
  ds_read_b128 v[80:83], v32 offset:128
  ds_read_b128 v[96:99], v32 offset:256
  ds_read_b128 v[68:71], v32 offset:12288
  ds_read_b128 v[84:87], v32 offset:12416
  ds_read_b128 v[100:103], v32 offset:12544
  ds_read_b128 v[72:75], v33 offset:0
  ds_read_b128 v[88:91], v33 offset:128
  ds_read_b128 v[104:107], v33 offset:256
  ds_read_b128 v[76:79], v33 offset:12288
  ds_read_b128 v[92:95], v33 offset:12416
  ds_read_b128 v[108:111], v33 offset:12544
  s_waitcnt lgkmcnt(0)
  s_add_u32 m0, s50, 73728
  s_add_u32 s63, s63, 98304
  buffer_load_dwordx4 v23, s[16:19], s63 offen offset:0  lds
  buffer_load_dwordx4 v24, s[16:19], s63 offen offset:1024  lds
  buffer_load_dwordx4 v25, s[16:19], s63 offen offset:2048  lds
  s_add_u32 m0, s50, 86016
  s_add_u32 s64, s64, 98304
  buffer_load_dwordx4 v26, s[20:23], s64 offen offset:0  lds
  buffer_load_dwordx4 v27, s[20:23], s64 offen offset:1024  lds
  buffer_load_dwordx4 v28, s[20:23], s64 offen offset:2048  lds
  s_add_u32 m0, s50, 98304
  s_add_u32 s63, s63, 98304
  buffer_load_dwordx4 v23, s[16:19], s63 offen offset:0  lds
  buffer_load_dwordx4 v24, s[16:19], s63 offen offset:1024  lds
  buffer_load_dwordx4 v25, s[16:19], s63 offen offset:2048  lds
  s_add_u32 m0, s50, 110592
  s_add_u32 s64, s64, 98304
  buffer_load_dwordx4 v26, s[20:23], s64 offen offset:0  lds
  buffer_load_dwordx4 v27, s[20:23], s64 offen offset:1024  lds
  buffer_load_dwordx4 v28, s[20:23], s64 offen offset:2048  lds
  s_waitcnt vmcnt(6)
  s_barrier
  s_add_u32 m0, s50, 122880
  s_add_u32 s63, s63, 98304
  buffer_load_dwordx4 v23, s[16:19], s63 offen offset:0  lds
  buffer_load_dwordx4 v24, s[16:19], s63 offen offset:1024  lds
  buffer_load_dwordx4 v25, s[16:19], s63 offen offset:2048  lds
  s_add_u32 m0, s50, 135168
  s_add_u32 s64, s64, 98304
  buffer_load_dwordx4 v26, s[20:23], s64 offen offset:0  lds
  buffer_load_dwordx4 v27, s[20:23], s64 offen offset:1024  lds
  buffer_load_dwordx4 v28, s[20:23], s64 offen offset:2048  lds
  s_waitcnt vmcnt(6)
  s_barrier
  s_add_u32 m0, s50, 12288
  s_add_u32 s64, s64, 98304
  buffer_load_dwordx4 v26, s[20:23], s64 offen offset:0  lds
  buffer_load_dwordx4 v27, s[20:23], s64 offen offset:1024  lds
  buffer_load_dwordx4 v28, s[20:23], s64 offen offset:2048  lds
  buffer_store_dwordx4 v[64:67], v30, s[28:31], s62 offen offset:0 sc0 sc1 nt
  buffer_store_dwordx4 v[80:83], v30, s[28:31], s62 offen offset:128 sc0 sc1 nt
  buffer_store_dwordx4 v[96:99], v30, s[28:31], s62 offen offset:256 sc0 sc1 nt
  buffer_store_dwordx4 v[68:71], v30, s[28:31], s62 offen offset:384 sc0 sc1 nt
  s_waitcnt vmcnt(7)
  s_barrier
  buffer_store_dwordx4 v[84:87], v30, s[28:31], s62 offen offset:512 sc0 sc1 nt
  buffer_store_dwordx4 v[100:103], v30, s[28:31], s62 offen offset:640 sc0 sc1 nt
  s_add_u32 s62, s62, 196608
  buffer_store_dwordx4 v[72:75], v30, s[28:31], s62 offen offset:0 sc0 sc1 nt
  buffer_store_dwordx4 v[88:91], v30, s[28:31], s62 offen offset:128 sc0 sc1 nt
  s_waitcnt vmcnt(8)
  s_barrier
  buffer_store_dwordx4 v[104:107], v30, s[28:31], s62 offen offset:256 sc0 sc1 nt
  buffer_store_dwordx4 v[76:79], v30, s[28:31], s62 offen offset:384 sc0 sc1 nt
  buffer_store_dwordx4 v[92:95], v30, s[28:31], s62 offen offset:512 sc0 sc1 nt
  buffer_store_dwordx4 v[108:111], v30, s[28:31], s62 offen offset:640 sc0 sc1 nt
  s_endpgm
.p2align 12
L_SH6:
  s_cbranch_execz RETH_R1
  s_add_u32 m0, s50, 24576
  s_sub_u32 s67, s55, 196608
  s_sub_u32 s62, s62, 196608
  buffer_load_dwordx4 v20, s[24:27], s67 offen offset:0 nt lds
  buffer_load_dwordx4 v21, s[24:27], s67 offen offset:1024 nt lds
  buffer_load_dwordx4 v22, s[24:27], s67 offen offset:2048 nt lds
  s_add_u32 m0, s50, 36864
  s_add_u32 s51, s67, 384
  buffer_load_dwordx4 v20, s[24:27], s51 offen offset:0 nt lds
  buffer_load_dwordx4 v21, s[24:27], s51 offen offset:1024 nt lds
  buffer_load_dwordx4 v22, s[24:27], s51 offen offset:2048 nt lds
  s_add_u32 m0, s50, 73728
  s_add_u32 s63, s63, 98304
  buffer_load_dwordx4 v23, s[16:19], s63 offen offset:0  lds
  buffer_load_dwordx4 v24, s[16:19], s63 offen offset:1024  lds
  buffer_load_dwordx4 v25, s[16:19], s63 offen offset:2048  lds
  s_add_u32 m0, s50, 86016
  s_add_u32 s64, s64, 98304
  buffer_load_dwordx4 v26, s[20:23], s64 offen offset:0  lds
  buffer_load_dwordx4 v27, s[20:23], s64 offen offset:1024  lds
  buffer_load_dwordx4 v28, s[20:23], s64 offen offset:2048  lds
  s_waitcnt vmcnt(12)
  s_barrier
  s_setprio 1
  s_add_u32 m0, s50, 98304
  s_add_u32 s63, s63, 98304
  buffer_load_dwordx4 v23, s[16:19], s63 offen offset:0  lds
  buffer_load_dwordx4 v24, s[16:19], s63 offen offset:1024  lds
  buffer_load_dwordx4 v25, s[16:19], s63 offen offset:2048  lds
  s_add_u32 m0, s50, 110592
  s_add_u32 s64, s64, 98304
  buffer_load_dwordx4 v26, s[20:23], s64 offen offset:0  lds
  buffer_load_dwordx4 v27, s[20:23], s64 offen offset:1024  lds
  buffer_load_dwordx4 v28, s[20:23], s64 offen offset:2048  lds
  s_waitcnt vmcnt(6)
  s_barrier
  s_add_u32 m0, s50, 122880
  s_add_u32 s63, s63, 98304
  buffer_load_dwordx4 v23, s[16:19], s63 offen offset:0  lds
  buffer_load_dwordx4 v24, s[16:19], s63 offen offset:1024  lds
  buffer_load_dwordx4 v25, s[16:19], s63 offen offset:2048  lds
  s_add_u32 m0, s50, 135168
  s_add_u32 s64, s64, 98304
  buffer_load_dwordx4 v26, s[20:23], s64 offen offset:0  lds
  buffer_load_dwordx4 v27, s[20:23], s64 offen offset:1024  lds
  buffer_load_dwordx4 v28, s[20:23], s64 offen offset:2048  lds
  s_add_u32 m0, s50, 0
  s_add_u32 s63, s63, 98304
  buffer_load_dwordx4 v23, s[16:19], s63 offen offset:0  lds
  buffer_load_dwordx4 v24, s[16:19], s63 offen offset:1024  lds
  buffer_load_dwordx4 v25, s[16:19], s63 offen offset:2048  lds
  s_add_u32 m0, s50, 12288
  s_add_u32 s64, s64, 98304
  buffer_load_dwordx4 v26, s[20:23], s64 offen offset:0  lds
  buffer_load_dwordx4 v27, s[20:23], s64 offen offset:1024  lds
  buffer_load_dwordx4 v28, s[20:23], s64 offen offset:2048  lds
  s_waitcnt vmcnt(12)
  s_barrier
  s_add_u32 m0, s50, 24576
  s_add_u32 s63, s63, 98304
  buffer_load_dwordx4 v23, s[16:19], s63 offen offset:0  lds
  buffer_load_dwordx4 v24, s[16:19], s63 offen offset:1024  lds
  buffer_load_dwordx4 v25, s[16:19], s63 offen offset:2048  lds
  s_add_u32 m0, s50, 36864
  s_add_u32 s64, s64, 98304
  buffer_load_dwordx4 v26, s[20:23], s64 offen offset:0  lds
  buffer_load_dwordx4 v27, s[20:23], s64 offen offset:1024  lds
  buffer_load_dwordx4 v28, s[20:23], s64 offen offset:2048  lds
  s_waitcnt vmcnt(12)
  s_barrier
  s_add_u32 m0, s50, 49152
  s_mov_b32 s18, s71
  s_mov_b32 s63, s70
  buffer_load_dwordx4 v23, s[16:19], s63 offen offset:0  lds
  buffer_load_dwordx4 v24, s[16:19], s63 offen offset:1024  lds
  buffer_load_dwordx4 v25, s[16:19], s63 offen offset:2048  lds
  s_add_u32 m0, s50, 61440
  s_add_u32 s64, s64, 98304
  buffer_load_dwordx4 v26, s[20:23], s64 offen offset:0  lds
  buffer_load_dwordx4 v27, s[20:23], s64 offen offset:1024  lds
  buffer_load_dwordx4 v28, s[20:23], s64 offen offset:2048  lds
  s_waitcnt vmcnt(12)
  s_barrier
  s_add_u32 m0, s50, 73728
  s_mov_b32 s26, s69
  s_mov_b32 s67, s68
  buffer_load_dwordx4 v20, s[24:27], s67 offen offset:0 nt lds
  buffer_load_dwordx4 v21, s[24:27], s67 offen offset:1024 nt lds
  buffer_load_dwordx4 v22, s[24:27], s67 offen offset:2048 nt lds
  s_add_u32 m0, s50, 86016
  s_add_u32 s51, s67, 384
  buffer_load_dwordx4 v20, s[24:27], s51 offen offset:0 nt lds
  buffer_load_dwordx4 v21, s[24:27], s51 offen offset:1024 nt lds
  buffer_load_dwordx4 v22, s[24:27], s51 offen offset:2048 nt lds
  s_waitcnt vmcnt(12)
  s_barrier
  s_add_u32 m0, s50, 98304
  s_add_u32 s67, s67, 196608
  buffer_load_dwordx4 v20, s[24:27], s67 offen offset:0 nt lds
  buffer_load_dwordx4 v21, s[24:27], s67 offen offset:1024 nt lds
  buffer_load_dwordx4 v22, s[24:27], s67 offen offset:2048 nt lds
  s_add_u32 m0, s50, 110592
  s_add_u32 s51, s67, 384
  buffer_load_dwordx4 v20, s[24:27], s51 offen offset:0 nt lds
  buffer_load_dwordx4 v21, s[24:27], s51 offen offset:1024 nt lds
  buffer_load_dwordx4 v22, s[24:27], s51 offen offset:2048 nt lds
  s_waitcnt vmcnt(0)
  s_barrier
  s_add_u32 m0, s50, 122880
  s_add_u32 s63, s63, 98304
  buffer_load_dwordx4 v23, s[16:19], s63 offen offset:0  lds
  buffer_load_dwordx4 v24, s[16:19], s63 offen offset:1024  lds
  buffer_load_dwordx4 v25, s[16:19], s63 offen offset:2048  lds
  s_add_u32 m0, s50, 135168
  s_mov_b32 s22, s71
  s_mov_b32 s64, s70
  buffer_load_dwordx4 v26, s[20:23], s64 offen offset:0  lds
  buffer_load_dwordx4 v27, s[20:23], s64 offen offset:1024  lds
  buffer_load_dwordx4 v28, s[20:23], s64 offen offset:2048  lds
  s_waitcnt vmcnt(0)
  s_barrier
  v_add_u32 v32, 73728, v29
  v_add_u32 v33, 98304, v29
  ds_read_b128 v[64:67], v32 offset:0
  ds_read_b128 v[80:83], v32 offset:128
  ds_read_b128 v[96:99], v32 offset:256
  ds_read_b128 v[68:71], v32 offset:12288
  ds_read_b128 v[84:87], v32 offset:12416
  ds_read_b128 v[100:103], v32 offset:12544
  ds_read_b128 v[72:75], v33 offset:0
  ds_read_b128 v[88:91], v33 offset:128
  ds_read_b128 v[104:107], v33 offset:256
  ds_read_b128 v[76:79], v33 offset:12288
  ds_read_b128 v[92:95], v33 offset:12416
  ds_read_b128 v[108:111], v33 offset:12544
  s_waitcnt lgkmcnt(0)
  s_add_u32 m0, s50, 12288
  s_add_u32 s64, s64, 98304
  buffer_load_dwordx4 v26, s[20:23], s64 offen offset:0  lds
  buffer_load_dwordx4 v27, s[20:23], s64 offen offset:1024  lds
  buffer_load_dwordx4 v28, s[20:23], s64 offen offset:2048  lds
  buffer_store_dwordx4 v[64:67], v30, s[28:31], s62 offen offset:0 sc0 sc1 nt
  buffer_store_dwordx4 v[80:83], v30, s[28:31], s62 offen offset:128 sc0 sc1 nt
  buffer_store_dwordx4 v[96:99], v30, s[28:31], s62 offen offset:256 sc0 sc1 nt
  buffer_store_dwordx4 v[68:71], v30, s[28:31], s62 offen offset:384 sc0 sc1 nt
  buffer_store_dwordx4 v[84:87], v30, s[28:31], s62 offen offset:512 sc0 sc1 nt
  buffer_store_dwordx4 v[100:103], v30, s[28:31], s62 offen offset:640 sc0 sc1 nt
  s_waitcnt vmcnt(6)
  s_barrier
  s_add_u32 s62, s62, 196608
  buffer_store_dwordx4 v[72:75], v30, s[28:31], s62 offen offset:0 sc0 sc1 nt
  buffer_store_dwordx4 v[88:91], v30, s[28:31], s62 offen offset:128 sc0 sc1 nt
  buffer_store_dwordx4 v[104:107], v30, s[28:31], s62 offen offset:256 sc0 sc1 nt
  buffer_store_dwordx4 v[76:79], v30, s[28:31], s62 offen offset:384 sc0 sc1 nt
  buffer_store_dwordx4 v[92:95], v30, s[28:31], s62 offen offset:512 sc0 sc1 nt
  buffer_store_dwordx4 v[108:111], v30, s[28:31], s62 offen offset:640 sc0 sc1 nt
  s_endpgm
L_SH7:
  s_cbranch_execz RETH_R1
  s_add_u32 m0, s50, 24576
  s_sub_u32 s67, s55, 196608
  s_sub_u32 s62, s62, 196608
  buffer_load_dwordx4 v20, s[24:27], s67 offen offset:0 nt lds
  buffer_load_dwordx4 v21, s[24:27], s67 offen offset:1024 nt lds
  buffer_load_dwordx4 v22, s[24:27], s67 offen offset:2048 nt lds
  s_add_u32 m0, s50, 36864
  s_add_u32 s51, s67, 384
  buffer_load_dwordx4 v20, s[24:27], s51 offen offset:0 nt lds
  buffer_load_dwordx4 v21, s[24:27], s51 offen offset:1024 nt lds
  buffer_load_dwordx4 v22, s[24:27], s51 offen offset:2048 nt lds
  s_add_u32 m0, s50, 73728
  s_add_u32 s63, s63, 98304
  buffer_load_dwordx4 v23, s[16:19], s63 offen offset:0  lds
  buffer_load_dwordx4 v24, s[16:19], s63 offen offset:1024  lds
  buffer_load_dwordx4 v25, s[16:19], s63 offen offset:2048  lds
  s_add_u32 m0, s50, 86016
  s_add_u32 s64, s64, 98304
  buffer_load_dwordx4 v26, s[20:23], s64 offen offset:0  lds
  buffer_load_dwordx4 v27, s[20:23], s64 offen offset:1024  lds
  buffer_load_dwordx4 v28, s[20:23], s64 offen offset:2048  lds
  s_waitcnt vmcnt(12)
  s_barrier
  s_setprio 1
  s_add_u32 m0, s50, 98304
  s_add_u32 s63, s63, 98304
  buffer_load_dwordx4 v23, s[16:19], s63 offen offset:0  lds
  buffer_load_dwordx4 v24, s[16:19], s63 offen offset:1024  lds
  buffer_load_dwordx4 v25, s[16:19], s63 offen offset:2048  lds
  s_add_u32 m0, s50, 110592
  s_add_u32 s64, s64, 98304
  buffer_load_dwordx4 v26, s[20:23], s64 offen offset:0  lds
  buffer_load_dwordx4 v27, s[20:23], s64 offen offset:1024  lds
  buffer_load_dwordx4 v28, s[20:23], s64 offen offset:2048  lds
  s_waitcnt vmcnt(6)
  s_barrier
  s_add_u32 m0, s50, 122880
  s_add_u32 s63, s63, 98304
  buffer_load_dwordx4 v23, s[16:19], s63 offen offset:0  lds
  buffer_load_dwordx4 v24, s[16:19], s63 offen offset:1024  lds
  buffer_load_dwordx4 v25, s[16:19], s63 offen offset:2048  lds
  s_add_u32 m0, s50, 135168
  s_add_u32 s64, s64, 98304
  buffer_load_dwordx4 v26, s[20:23], s64 offen offset:0  lds
  buffer_load_dwordx4 v27, s[20:23], s64 offen offset:1024  lds
  buffer_load_dwordx4 v28, s[20:23], s64 offen offset:2048  lds
  s_add_u32 m0, s50, 0
  s_mov_b32 s18, s71
  s_mov_b32 s63, s70
  buffer_load_dwordx4 v23, s[16:19], s63 offen offset:0  lds
  buffer_load_dwordx4 v24, s[16:19], s63 offen offset:1024  lds
  buffer_load_dwordx4 v25, s[16:19], s63 offen offset:2048  lds
  s_add_u32 m0, s50, 12288
  s_add_u32 s64, s64, 98304
  buffer_load_dwordx4 v26, s[20:23], s64 offen offset:0  lds
  buffer_load_dwordx4 v27, s[20:23], s64 offen offset:1024  lds
  buffer_load_dwordx4 v28, s[20:23], s64 offen offset:2048  lds
  s_waitcnt vmcnt(12)
  s_barrier
  s_add_u32 m0, s50, 24576
  s_mov_b32 s26, s69
  s_mov_b32 s67, s68
  buffer_load_dwordx4 v20, s[24:27], s67 offen offset:0 nt lds
  buffer_load_dwordx4 v21, s[24:27], s67 offen offset:1024 nt lds
  buffer_load_dwordx4 v22, s[24:27], s67 offen offset:2048 nt lds
  s_add_u32 m0, s50, 36864
  s_add_u32 s51, s67, 384
  buffer_load_dwordx4 v20, s[24:27], s51 offen offset:0 nt lds
  buffer_load_dwordx4 v21, s[24:27], s51 offen offset:1024 nt lds
  buffer_load_dwordx4 v22, s[24:27], s51 offen offset:2048 nt lds
  s_add_u32 m0, s50, 49152
  s_add_u32 s67, s67, 196608
  buffer_load_dwordx4 v20, s[24:27], s67 offen offset:0 nt lds
  buffer_load_dwordx4 v21, s[24:27], s67 offen offset:1024 nt lds
  buffer_load_dwordx4 v22, s[24:27], s67 offen offset:2048 nt lds
  s_add_u32 m0, s50, 61440
  s_add_u32 s51, s67, 384
  buffer_load_dwordx4 v20, s[24:27], s51 offen offset:0 nt lds
  buffer_load_dwordx4 v21, s[24:27], s51 offen offset:1024 nt lds
  buffer_load_dwordx4 v22, s[24:27], s51 offen offset:2048 nt lds
  s_waitcnt vmcnt(18)
  s_barrier
  s_waitcnt vmcnt(0)
  s_barrier
  s_add_u32 m0, s50, 73728
  s_add_u32 s63, s63, 98304
  buffer_load_dwordx4 v23, s[16:19], s63 offen offset:0  lds
  buffer_load_dwordx4 v24, s[16:19], s63 offen offset:1024  lds
  buffer_load_dwordx4 v25, s[16:19], s63 offen offset:2048  lds
  s_add_u32 m0, s50, 86016
  s_mov_b32 s22, s71
  s_mov_b32 s64, s70
  buffer_load_dwordx4 v26, s[20:23], s64 offen offset:0  lds
  buffer_load_dwordx4 v27, s[20:23], s64 offen offset:1024  lds
  buffer_load_dwordx4 v28, s[20:23], s64 offen offset:2048  lds
  s_waitcnt vmcnt(0)
  s_barrier
  v_add_u32 v32, 24576, v29
  v_add_u32 v33, 49152, v29
  ds_read_b128 v[64:67], v32 offset:0
  ds_read_b128 v[80:83], v32 offset:128
  ds_read_b128 v[96:99], v32 offset:256
  ds_read_b128 v[68:71], v32 offset:12288
  ds_read_b128 v[84:87], v32 offset:12416
  ds_read_b128 v[100:103], v32 offset:12544
  ds_read_b128 v[72:75], v33 offset:0
  ds_read_b128 v[88:91], v33 offset:128
  ds_read_b128 v[104:107], v33 offset:256
  ds_read_b128 v[76:79], v33 offset:12288
  ds_read_b128 v[92:95], v33 offset:12416
  ds_read_b128 v[108:111], v33 offset:12544
  s_waitcnt lgkmcnt(0)
  s_add_u32 m0, s50, 98304
  s_add_u32 s63, s63, 98304
  buffer_load_dwordx4 v23, s[16:19], s63 offen offset:0  lds
  buffer_load_dwordx4 v24, s[16:19], s63 offen offset:1024  lds
  buffer_load_dwordx4 v25, s[16:19], s63 offen offset:2048  lds
  s_add_u32 m0, s50, 110592
  s_add_u32 s64, s64, 98304
  buffer_load_dwordx4 v26, s[20:23], s64 offen offset:0  lds
  buffer_load_dwordx4 v27, s[20:23], s64 offen offset:1024  lds
  buffer_load_dwordx4 v28, s[20:23], s64 offen offset:2048  lds
  s_add_u32 m0, s50, 122880
  s_add_u32 s63, s63, 98304
  buffer_load_dwordx4 v23, s[16:19], s63 offen offset:0  lds
  buffer_load_dwordx4 v24, s[16:19], s63 offen offset:1024  lds
  buffer_load_dwordx4 v25, s[16:19], s63 offen offset:2048  lds
  s_add_u32 m0, s50, 135168
  s_add_u32 s64, s64, 98304
  buffer_load_dwordx4 v26, s[20:23], s64 offen offset:0  lds
  buffer_load_dwordx4 v27, s[20:23], s64 offen offset:1024  lds
  buffer_load_dwordx4 v28, s[20:23], s64 offen offset:2048  lds
  s_waitcnt vmcnt(6)
  s_barrier
  s_add_u32 m0, s50, 12288
  s_add_u32 s64, s64, 98304
  buffer_load_dwordx4 v26, s[20:23], s64 offen offset:0  lds
  buffer_load_dwordx4 v27, s[20:23], s64 offen offset:1024  lds
  buffer_load_dwordx4 v28, s[20:23], s64 offen offset:2048  lds
  s_waitcnt vmcnt(3)
  s_barrier
  buffer_store_dwordx4 v[64:67], v30, s[28:31], s62 offen offset:0 sc0 sc1 nt
  buffer_store_dwordx4 v[80:83], v30, s[28:31], s62 offen offset:128 sc0 sc1 nt
  buffer_store_dwordx4 v[96:99], v30, s[28:31], s62 offen offset:256 sc0 sc1 nt
  buffer_store_dwordx4 v[68:71], v30, s[28:31], s62 offen offset:384 sc0 sc1 nt
  buffer_store_dwordx4 v[84:87], v30, s[28:31], s62 offen offset:512 sc0 sc1 nt
  buffer_store_dwordx4 v[100:103], v30, s[28:31], s62 offen offset:640 sc0 sc1 nt
  s_waitcnt vmcnt(6)
  s_barrier
  s_add_u32 s62, s62, 196608
  buffer_store_dwordx4 v[72:75], v30, s[28:31], s62 offen offset:0 sc0 sc1 nt
  buffer_store_dwordx4 v[88:91], v30, s[28:31], s62 offen offset:128 sc0 sc1 nt
  buffer_store_dwordx4 v[104:107], v30, s[28:31], s62 offen offset:256 sc0 sc1 nt
  buffer_store_dwordx4 v[76:79], v30, s[28:31], s62 offen offset:384 sc0 sc1 nt
  buffer_store_dwordx4 v[92:95], v30, s[28:31], s62 offen offset:512 sc0 sc1 nt
  buffer_store_dwordx4 v[108:111], v30, s[28:31], s62 offen offset:640 sc0 sc1 nt
  s_endpgm
L_SH1:
  s_cbranch_execz RETH_R1
  s_add_u32 m0, s50, 73728
  s_mov_b32 s18, s71
  s_mov_b32 s63, s70
  buffer_load_dwordx4 v23, s[16:19], s63 offen offset:0  lds
  buffer_load_dwordx4 v24, s[16:19], s63 offen offset:1024  lds
  buffer_load_dwordx4 v25, s[16:19], s63 offen offset:2048  lds
  s_add_u32 m0, s50, 86016
  s_add_u32 s64, s64, 98304
  buffer_load_dwordx4 v26, s[20:23], s64 offen offset:0  lds
  buffer_load_dwordx4 v27, s[20:23], s64 offen offset:1024  lds
  buffer_load_dwordx4 v28, s[20:23], s64 offen offset:2048  lds
  s_waitcnt vmcnt(6)
  s_barrier
  s_setprio 1
  s_add_u32 m0, s50, 98304
  s_mov_b32 s26, s69
  s_mov_b32 s67, s68
  buffer_load_dwordx4 v20, s[24:27], s67 offen offset:0 nt lds
  buffer_load_dwordx4 v21, s[24:27], s67 offen offset:1024 nt lds
  buffer_load_dwordx4 v22, s[24:27], s67 offen offset:2048 nt lds
  s_add_u32 m0, s50, 110592
  s_add_u32 s51, s67, 384
  buffer_load_dwordx4 v20, s[24:27], s51 offen offset:0 nt lds
  buffer_load_dwordx4 v21, s[24:27], s51 offen offset:1024 nt lds
  buffer_load_dwordx4 v22, s[24:27], s51 offen offset:2048 nt lds
  s_add_u32 m0, s50, 122880
  s_add_u32 s67, s67, 196608
  buffer_load_dwordx4 v20, s[24:27], s67 offen offset:0 nt lds
  buffer_load_dwordx4 v21, s[24:27], s67 offen offset:1024 nt lds
  buffer_load_dwordx4 v22, s[24:27], s67 offen offset:2048 nt lds
  s_add_u32 m0, s50, 135168
  s_add_u32 s51, s67, 384
  buffer_load_dwordx4 v20, s[24:27], s51 offen offset:0 nt lds
  buffer_load_dwordx4 v21, s[24:27], s51 offen offset:1024 nt lds
  buffer_load_dwordx4 v22, s[24:27], s51 offen offset:2048 nt lds
  s_waitcnt vmcnt(0)
  s_barrier
  s_add_u32 m0, s50, 0
  s_add_u32 s63, s63, 98304
  buffer_load_dwordx4 v23, s[16:19], s63 offen offset:0  lds
  buffer_load_dwordx4 v24, s[16:19], s63 offen offset:1024  lds
  buffer_load_dwordx4 v25, s[16:19], s63 offen offset:2048  lds
  s_add_u32 m0, s50, 12288
  s_mov_b32 s22, s71
  s_mov_b32 s64, s70
  buffer_load_dwordx4 v26, s[20:23], s64 offen offset:0  lds
  buffer_load_dwordx4 v27, s[20:23], s64 offen offset:1024  lds
  buffer_load_dwordx4 v28, s[20:23], s64 offen offset:2048  lds
  s_add_u32 m0, s50, 24576
  s_add_u32 s63, s63, 98304
  buffer_load_dwordx4 v23, s[16:19], s63 offen offset:0  lds
  buffer_load_dwordx4 v24, s[16:19], s63 offen offset:1024  lds
  buffer_load_dwordx4 v25, s[16:19], s63 offen offset:2048  lds
  s_add_u32 m0, s50, 36864
  s_add_u32 s64, s64, 98304
  buffer_load_dwordx4 v26, s[20:23], s64 offen offset:0  lds
  buffer_load_dwordx4 v27, s[20:23], s64 offen offset:1024  lds
  buffer_load_dwordx4 v28, s[20:23], s64 offen offset:2048  lds
  s_waitcnt vmcnt(6)
  s_barrier
  v_add_u32 v32, 98304, v29
  v_add_u32 v33, 122880, v29
  ds_read_b128 v[72:75], v33 offset:0
  ds_read_b128 v[88:91], v33 offset:128
  ds_read_b128 v[104:107], v33 offset:256
  ds_read_b128 v[76:79], v33 offset:12288
  ds_read_b128 v[92:95], v33 offset:12416
  ds_read_b128 v[108:111], v33 offset:12544
  s_waitcnt lgkmcnt(0)
  s_add_u32 m0, s50, 49152
  s_add_u32 s63, s63, 98304
  buffer_load_dwordx4 v23, s[16:19], s63 offen offset:0  lds
  buffer_load_dwordx4 v24, s[16:19], s63 offen offset:1024  lds
  buffer_load_dwordx4 v25, s[16:19], s63 offen offset:2048  lds
  s_add_u32 m0, s50, 61440
  s_add_u32 s64, s64, 98304
  buffer_load_dwordx4 v26, s[20:23], s64 offen offset:0  lds
  buffer_load_dwordx4 v27, s[20:23], s64 offen offset:1024  lds
  buffer_load_dwordx4 v28, s[20:23], s64 offen offset:2048  lds
  s_waitcnt vmcnt(6)
  s_barrier
  s_add_u32 m0, s50, 73728
  s_add_u32 s63, s63, 98304
  buffer_load_dwordx4 v23, s[16:19], s63 offen offset:0  lds
  buffer_load_dwordx4 v24, s[16:19], s63 offen offset:1024  lds
  buffer_load_dwordx4 v25, s[16:19], s63 offen offset:2048  lds
  s_add_u32 m0, s50, 86016
  s_add_u32 s64, s64, 98304
  buffer_load_dwordx4 v26, s[20:23], s64 offen offset:0  lds
  buffer_load_dwordx4 v27, s[20:23], s64 offen offset:1024  lds
  buffer_load_dwordx4 v28, s[20:23], s64 offen offset:2048  lds
  s_waitcnt vmcnt(6)
  s_barrier
  s_add_u32 m0, s50, 98304
  s_add_u32 s63, s63, 98304
  buffer_load_dwordx4 v23, s[16:19], s63 offen offset:0  lds
  buffer_load_dwordx4 v24, s[16:19], s63 offen offset:1024  lds
  buffer_load_dwordx4 v25, s[16:19], s63 offen offset:2048  lds
  s_add_u32 m0, s50, 110592
  s_add_u32 s64, s64, 98304
  buffer_load_dwordx4 v26, s[20:23], s64 offen offset:0  lds
  buffer_load_dwordx4 v27, s[20:23], s64 offen offset:1024  lds
  buffer_load_dwordx4 v28, s[20:23], s64 offen offset:2048  lds
  buffer_store_dwordx4 v[72:75], v30, s[28:31], s62 offen offset:0 sc0 sc1 nt
  s_waitcnt vmcnt(7)
  s_barrier
  s_add_u32 m0, s50, 122880
  s_add_u32 s63, s63, 98304
  buffer_load_dwordx4 v23, s[16:19], s63 offen offset:0  lds
  buffer_load_dwordx4 v24, s[16:19], s63 offen offset:1024  lds
  buffer_load_dwordx4 v25, s[16:19], s63 offen offset:2048  lds
  s_add_u32 m0, s50, 135168
  s_add_u32 s64, s64, 98304
  buffer_load_dwordx4 v26, s[20:23], s64 offen offset:0  lds
  buffer_load_dwordx4 v27, s[20:23], s64 offen offset:1024  lds
  buffer_load_dwordx4 v28, s[20:23], s64 offen offset:2048  lds
  buffer_store_dwordx4 v[88:91], v30, s[28:31], s62 offen offset:128 sc0 sc1 nt
  s_waitcnt vmcnt(8)
  s_barrier
  s_add_u32 m0, s50, 0
  s_add_u32 s63, s63, 98304
  buffer_load_dwordx4 v23, s[16:19], s63 offen offset:0  lds
  buffer_load_dwordx4 v24, s[16:19], s63 offen offset:1024  lds
  buffer_load_dwordx4 v25, s[16:19], s63 offen offset:2048  lds
  s_add_u32 m0, s50, 12288
  s_add_u32 s64, s64, 98304
  buffer_load_dwordx4 v26, s[20:23], s64 offen offset:0  lds
  buffer_load_dwordx4 v27, s[20:23], s64 offen offset:1024  lds
  buffer_load_dwordx4 v28, s[20:23], s64 offen offset:2048  lds
  buffer_store_dwordx4 v[104:107], v30, s[28:31], s62 offen offset:256 sc0 sc1 nt
  s_waitcnt vmcnt(8)
  s_barrier
  s_add_u32 m0, s50, 36864
  s_add_u32 s64, s64, 98304
  buffer_load_dwordx4 v26, s[20:23], s64 offen offset:0  lds
  buffer_load_dwordx4 v27, s[20:23], s64 offen offset:1024  lds
  buffer_load_dwordx4 v28, s[20:23], s64 offen offset:2048  lds
  buffer_store_dwordx4 v[76:79], v30, s[28:31], s62 offen offset:384 sc0 sc1 nt
  s_waitcnt vmcnt(5)
  s_barrier
  buffer_store_dwordx4 v[92:95], v30, s[28:31], s62 offen offset:512 sc0 sc1 nt
  s_waitcnt vmcnt(2)
  s_barrier
  buffer_store_dwordx4 v[108:111], v30, s[28:31], s62 offen offset:640 sc0 sc1 nt
  s_endpgm
.p2align 12
RARE1_T0:
  v_mov_b32 v12, v10
  s_nop 1
  v_permlane32_swap_b32 v10, v12
  v_max_f32 v10, v10, v12
  v_mul_f32 v10, s41, v10
  v_max_f32 v10, v10, v7
  v_sub_f32 v9, v7, v10
  v_exp_f32 v9, v9
  v_mov_b32 v7, v10
  v_mul_f32 v8, v8, v9
  s_branch RET1_T0
RARE2_T0:
  s_nop 15
  v_mul_f32 v160, v160, v9
  v_mul_f32 v161, v161, v9
  v_mul_f32 v162, v162, v9
  v_mul_f32 v163, v163, v9
  v_mul_f32 v164, v164, v9
  v_mul_f32 v165, v165, v9
  v_mul_f32 v166, v166, v9
  v_mul_f32 v167, v167, v9
  v_mul_f32 v168, v168, v9
  v_mul_f32 v169, v169, v9
  v_mul_f32 v170, v170, v9
  v_mul_f32 v171, v171, v9
  v_mul_f32 v172, v172, v9
  v_mul_f32 v173, v173, v9
  v_mul_f32 v174, v174, v9
  v_mul_f32 v175, v175, v9
  v_mul_f32 v176, v176, v9
  v_mul_f32 v177, v177, v9
  v_mul_f32 v178, v178, v9
  v_mul_f32 v179, v179, v9
  v_mul_f32 v180, v180, v9
  v_mul_f32 v181, v181, v9
  v_mul_f32 v182, v182, v9
  v_mul_f32 v183, v183, v9
  v_mul_f32 v184, v184, v9
  v_mul_f32 v185, v185, v9
  v_mul_f32 v186, v186, v9
  v_mul_f32 v187, v187, v9
  v_mul_f32 v188, v188, v9
  v_mul_f32 v189, v189, v9
  v_mul_f32 v190, v190, v9
  v_mul_f32 v191, v191, v9
  v_mul_f32 v192, v192, v9
  v_mul_f32 v193, v193, v9
  v_mul_f32 v194, v194, v9
  v_mul_f32 v195, v195, v9
  v_mul_f32 v196, v196, v9
  v_mul_f32 v197, v197, v9
  v_mul_f32 v198, v198, v9
  v_mul_f32 v199, v199, v9
  v_mul_f32 v200, v200, v9
  v_mul_f32 v201, v201, v9
  v_mul_f32 v202, v202, v9
  v_mul_f32 v203, v203, v9
  v_mul_f32 v204, v204, v9
  v_mul_f32 v205, v205, v9
  v_mul_f32 v206, v206, v9
  v_mul_f32 v207, v207, v9
  v_mul_f32 v208, v208, v9
  v_mul_f32 v209, v209, v9
  v_mul_f32 v210, v210, v9
  v_mul_f32 v211, v211, v9
  v_mul_f32 v212, v212, v9
  v_mul_f32 v213, v213, v9
  v_mul_f32 v214, v214, v9
  v_mul_f32 v215, v215, v9
  v_mul_f32 v216, v216, v9
  v_mul_f32 v217, v217, v9
  v_mul_f32 v218, v218, v9
  v_mul_f32 v219, v219, v9
  v_mul_f32 v220, v220, v9
  v_mul_f32 v221, v221, v9
  v_mul_f32 v222, v222, v9
  v_mul_f32 v223, v223, v9
  v_mul_f32 v224, v224, v9
  v_mul_f32 v225, v225, v9
  v_mul_f32 v226, v226, v9
  v_mul_f32 v227, v227, v9
  v_mul_f32 v228, v228, v9
  v_mul_f32 v229, v229, v9
  v_mul_f32 v230, v230, v9
  v_mul_f32 v231, v231, v9
  v_mul_f32 v232, v232, v9
  v_mul_f32 v233, v233, v9
  v_mul_f32 v234, v234, v9
  v_mul_f32 v235, v235, v9
  v_mul_f32 v236, v236, v9
  v_mul_f32 v237, v237, v9
  v_mul_f32 v238, v238, v9
  v_mul_f32 v239, v239, v9
  v_mul_f32 v240, v240, v9
  v_mul_f32 v241, v241, v9
  v_mul_f32 v242, v242, v9
  v_mul_f32 v243, v243, v9
  v_mul_f32 v244, v244, v9
  v_mul_f32 v245, v245, v9
  v_mul_f32 v246, v246, v9
  v_mul_f32 v247, v247, v9
  v_mul_f32 v248, v248, v9
  v_mul_f32 v249, v249, v9
  v_mul_f32 v250, v250, v9
  v_mul_f32 v251, v251, v9
  v_mul_f32 v252, v252, v9
  v_mul_f32 v253, v253, v9
  v_mul_f32 v254, v254, v9
  v_mul_f32 v255, v255, v9
  s_nop 1
  s_branch RET2_T0
RARE1_T1:
  v_mov_b32 v12, v10
  s_nop 1
  v_permlane32_swap_b32 v10, v12
  v_max_f32 v10, v10, v12
  v_mul_f32 v10, s41, v10
  v_max_f32 v10, v10, v7
  v_sub_f32 v9, v7, v10
  v_exp_f32 v9, v9
  v_mov_b32 v7, v10
  v_mul_f32 v8, v8, v9
  s_branch RET1_T1
RARE2_T1:
  s_nop 15
  v_mul_f32 v160, v160, v9
  v_mul_f32 v161, v161, v9
  v_mul_f32 v162, v162, v9
  v_mul_f32 v163, v163, v9
  v_mul_f32 v164, v164, v9
  v_mul_f32 v165, v165, v9
  v_mul_f32 v166, v166, v9
  v_mul_f32 v167, v167, v9
  v_mul_f32 v168, v168, v9
  v_mul_f32 v169, v169, v9
  v_mul_f32 v170, v170, v9
  v_mul_f32 v171, v171, v9
  v_mul_f32 v172, v172, v9
  v_mul_f32 v173, v173, v9
  v_mul_f32 v174, v174, v9
  v_mul_f32 v175, v175, v9
  v_mul_f32 v176, v176, v9
  v_mul_f32 v177, v177, v9
  v_mul_f32 v178, v178, v9
  v_mul_f32 v179, v179, v9
  v_mul_f32 v180, v180, v9
  v_mul_f32 v181, v181, v9
  v_mul_f32 v182, v182, v9
  v_mul_f32 v183, v183, v9
  v_mul_f32 v184, v184, v9
  v_mul_f32 v185, v185, v9
  v_mul_f32 v186, v186, v9
  v_mul_f32 v187, v187, v9
  v_mul_f32 v188, v188, v9
  v_mul_f32 v189, v189, v9
  v_mul_f32 v190, v190, v9
  v_mul_f32 v191, v191, v9
  v_mul_f32 v192, v192, v9
  v_mul_f32 v193, v193, v9
  v_mul_f32 v194, v194, v9
  v_mul_f32 v195, v195, v9
  v_mul_f32 v196, v196, v9
  v_mul_f32 v197, v197, v9
  v_mul_f32 v198, v198, v9
  v_mul_f32 v199, v199, v9
  v_mul_f32 v200, v200, v9
  v_mul_f32 v201, v201, v9
  v_mul_f32 v202, v202, v9
  v_mul_f32 v203, v203, v9
  v_mul_f32 v204, v204, v9
  v_mul_f32 v205, v205, v9
  v_mul_f32 v206, v206, v9
  v_mul_f32 v207, v207, v9
  v_mul_f32 v208, v208, v9
  v_mul_f32 v209, v209, v9
  v_mul_f32 v210, v210, v9
  v_mul_f32 v211, v211, v9
  v_mul_f32 v212, v212, v9
  v_mul_f32 v213, v213, v9
  v_mul_f32 v214, v214, v9
  v_mul_f32 v215, v215, v9
  v_mul_f32 v216, v216, v9
  v_mul_f32 v217, v217, v9
  v_mul_f32 v218, v218, v9
  v_mul_f32 v219, v219, v9
  v_mul_f32 v220, v220, v9
  v_mul_f32 v221, v221, v9
  v_mul_f32 v222, v222, v9
  v_mul_f32 v223, v223, v9
  v_mul_f32 v224, v224, v9
  v_mul_f32 v225, v225, v9
  v_mul_f32 v226, v226, v9
  v_mul_f32 v227, v227, v9
  v_mul_f32 v228, v228, v9
  v_mul_f32 v229, v229, v9
  v_mul_f32 v230, v230, v9
  v_mul_f32 v231, v231, v9
  v_mul_f32 v232, v232, v9
  v_mul_f32 v233, v233, v9
  v_mul_f32 v234, v234, v9
  v_mul_f32 v235, v235, v9
  v_mul_f32 v236, v236, v9
  v_mul_f32 v237, v237, v9
  v_mul_f32 v238, v238, v9
  v_mul_f32 v239, v239, v9
  v_mul_f32 v240, v240, v9
  v_mul_f32 v241, v241, v9
  v_mul_f32 v242, v242, v9
  v_mul_f32 v243, v243, v9
  v_mul_f32 v244, v244, v9
  v_mul_f32 v245, v245, v9
  v_mul_f32 v246, v246, v9
  v_mul_f32 v247, v247, v9
  v_mul_f32 v248, v248, v9
  v_mul_f32 v249, v249, v9
  v_mul_f32 v250, v250, v9
  v_mul_f32 v251, v251, v9
  v_mul_f32 v252, v252, v9
  v_mul_f32 v253, v253, v9
  v_mul_f32 v254, v254, v9
  v_mul_f32 v255, v255, v9
  s_nop 1
  s_branch RET2_T1
RARE1_T0z:
  v_mov_b32 v12, v10
  s_nop 1
  v_permlane32_swap_b32 v10, v12
  v_max_f32 v10, v10, v12
  v_mul_f32 v10, s41, v10
  v_max_f32 v10, v10, v7
  v_sub_f32 v9, v7, v10
  v_exp_f32 v9, v9
  v_mov_b32 v7, v10
  v_mul_f32 v8, v8, v9
  s_branch RET1_T0z
RARE2_T0z:
  s_nop 15
  v_mul_f32 v160, v160, v9
  v_mul_f32 v161, v161, v9
  v_mul_f32 v162, v162, v9
  v_mul_f32 v163, v163, v9
  v_mul_f32 v164, v164, v9
  v_mul_f32 v165, v165, v9
  v_mul_f32 v166, v166, v9
  v_mul_f32 v167, v167, v9
  v_mul_f32 v168, v168, v9
  v_mul_f32 v169, v169, v9
  v_mul_f32 v170, v170, v9
  v_mul_f32 v171, v171, v9
  v_mul_f32 v172, v172, v9
  v_mul_f32 v173, v173, v9
  v_mul_f32 v174, v174, v9
  v_mul_f32 v175, v175, v9
  v_mul_f32 v176, v176, v9
  v_mul_f32 v177, v177, v9
  v_mul_f32 v178, v178, v9
  v_mul_f32 v179, v179, v9
  v_mul_f32 v180, v180, v9
  v_mul_f32 v181, v181, v9
  v_mul_f32 v182, v182, v9
  v_mul_f32 v183, v183, v9
  v_mul_f32 v184, v184, v9
  v_mul_f32 v185, v185, v9
  v_mul_f32 v186, v186, v9
  v_mul_f32 v187, v187, v9
  v_mul_f32 v188, v188, v9
  v_mul_f32 v189, v189, v9
  v_mul_f32 v190, v190, v9
  v_mul_f32 v191, v191, v9
  v_mul_f32 v192, v192, v9
  v_mul_f32 v193, v193, v9
  v_mul_f32 v194, v194, v9
  v_mul_f32 v195, v195, v9
  v_mul_f32 v196, v196, v9
  v_mul_f32 v197, v197, v9
  v_mul_f32 v198, v198, v9
  v_mul_f32 v199, v199, v9
  v_mul_f32 v200, v200, v9
  v_mul_f32 v201, v201, v9
  v_mul_f32 v202, v202, v9
  v_mul_f32 v203, v203, v9
  v_mul_f32 v204, v204, v9
  v_mul_f32 v205, v205, v9
  v_mul_f32 v206, v206, v9
  v_mul_f32 v207, v207, v9
  v_mul_f32 v208, v208, v9
  v_mul_f32 v209, v209, v9
  v_mul_f32 v210, v210, v9
  v_mul_f32 v211, v211, v9
  v_mul_f32 v212, v212, v9
  v_mul_f32 v213, v213, v9
  v_mul_f32 v214, v214, v9
  v_mul_f32 v215, v215, v9
  v_mul_f32 v216, v216, v9
  v_mul_f32 v217, v217, v9
  v_mul_f32 v218, v218, v9
  v_mul_f32 v219, v219, v9
  v_mul_f32 v220, v220, v9
  v_mul_f32 v221, v221, v9
  v_mul_f32 v222, v222, v9
  v_mul_f32 v223, v223, v9
  v_mul_f32 v224, v224, v9
  v_mul_f32 v225, v225, v9
  v_mul_f32 v226, v226, v9
  v_mul_f32 v227, v227, v9
  v_mul_f32 v228, v228, v9
  v_mul_f32 v229, v229, v9
  v_mul_f32 v230, v230, v9
  v_mul_f32 v231, v231, v9
  v_mul_f32 v232, v232, v9
  v_mul_f32 v233, v233, v9
  v_mul_f32 v234, v234, v9
  v_mul_f32 v235, v235, v9
  v_mul_f32 v236, v236, v9
  v_mul_f32 v237, v237, v9
  v_mul_f32 v238, v238, v9
  v_mul_f32 v239, v239, v9
  v_mul_f32 v240, v240, v9
  v_mul_f32 v241, v241, v9
  v_mul_f32 v242, v242, v9
  v_mul_f32 v243, v243, v9
  v_mul_f32 v244, v244, v9
  v_mul_f32 v245, v245, v9
  v_mul_f32 v246, v246, v9
  v_mul_f32 v247, v247, v9
  v_mul_f32 v248, v248, v9
  v_mul_f32 v249, v249, v9
  v_mul_f32 v250, v250, v9
  v_mul_f32 v251, v251, v9
  v_mul_f32 v252, v252, v9
  v_mul_f32 v253, v253, v9
  v_mul_f32 v254, v254, v9
  v_mul_f32 v255, v255, v9
  s_nop 1
  s_branch RET2_T0z
RARES_0:
  v_max3_f32 v10, v80, v81, v82
  v_max3_f32 v11, v83, v84, v85
  v_max3_f32 v10, v10, v86, v87
  v_max3_f32 v11, v11, v88, v89
  v_max3_f32 v10, v10, v90, v91
  v_max3_f32 v11, v11, v92, v93
  v_max3_f32 v10, v10, v94, v95
  v_max_f32 v10, v10, v11
  v_mov_b32 v12, v10
  s_nop 1
  v_permlane32_swap_b32 v10, v12
  v_max3_f32 v10, v10, v12, 0
  v_add_f32 v7, v7, v10
  v_exp_f32 v11, -v10
  v_sub_f32 v80, v80, v10
  v_sub_f32 v81, v81, v10
  v_sub_f32 v82, v82, v10
  v_sub_f32 v83, v83, v10
  v_sub_f32 v84, v84, v10
  v_sub_f32 v85, v85, v10
  v_sub_f32 v86, v86, v10
  v_sub_f32 v87, v87, v10
  v_sub_f32 v88, v88, v10
  v_sub_f32 v89, v89, v10
  v_sub_f32 v90, v90, v10
  v_sub_f32 v91, v91, v10
  v_sub_f32 v92, v92, v10
  v_sub_f32 v93, v93, v10
  v_sub_f32 v94, v94, v10
  v_sub_f32 v95, v95, v10
  v_mul_f32 v8, v8, v11
  v_mul_f32 v160, v160, v11
  v_mul_f32 v161, v161, v11
  v_mul_f32 v162, v162, v11
  v_mul_f32 v163, v163, v11
  v_mul_f32 v164, v164, v11
  v_mul_f32 v165, v165, v11
  v_mul_f32 v166, v166, v11
  v_mul_f32 v167, v167, v11
  v_mul_f32 v168, v168, v11
  v_mul_f32 v169, v169, v11
  v_mul_f32 v170, v170, v11
  v_mul_f32 v171, v171, v11
  v_mul_f32 v172, v172, v11
  v_mul_f32 v173, v173, v11
  v_mul_f32 v174, v174, v11
  v_mul_f32 v175, v175, v11
  v_mul_f32 v176, v176, v11
  v_mul_f32 v177, v177, v11
  v_mul_f32 v178, v178, v11
  v_mul_f32 v179, v179, v11
  v_mul_f32 v180, v180, v11
  v_mul_f32 v181, v181, v11
  v_mul_f32 v182, v182, v11
  v_mul_f32 v183, v183, v11
  v_mul_f32 v184, v184, v11
  v_mul_f32 v185, v185, v11
  v_mul_f32 v186, v186, v11
  v_mul_f32 v187, v187, v11
  v_mul_f32 v188, v188, v11
  v_mul_f32 v189, v189, v11
  v_mul_f32 v190, v190, v11
  v_mul_f32 v191, v191, v11
  v_mul_f32 v192, v192, v11
  v_mul_f32 v193, v193, v11
  v_mul_f32 v194, v194, v11
  v_mul_f32 v195, v195, v11
  v_mul_f32 v196, v196, v11
  v_mul_f32 v197, v197, v11
  v_mul_f32 v198, v198, v11
  v_mul_f32 v199, v199, v11
  v_mul_f32 v200, v200, v11
  v_mul_f32 v201, v201, v11
  v_mul_f32 v202, v202, v11
  v_mul_f32 v203, v203, v11
  v_mul_f32 v204, v204, v11
  v_mul_f32 v205, v205, v11
  v_mul_f32 v206, v206, v11
  v_mul_f32 v207, v207, v11
  v_mul_f32 v208, v208, v11
  v_mul_f32 v209, v209, v11
  v_mul_f32 v210, v210, v11
  v_mul_f32 v211, v211, v11
  v_mul_f32 v212, v212, v11
  v_mul_f32 v213, v213, v11
  v_mul_f32 v214, v214, v11
  v_mul_f32 v215, v215, v11
  v_mul_f32 v216, v216, v11
  v_mul_f32 v217, v217, v11
  v_mul_f32 v218, v218, v11
  v_mul_f32 v219, v219, v11
  v_mul_f32 v220, v220, v11
  v_mul_f32 v221, v221, v11
  v_mul_f32 v222, v222, v11
  v_mul_f32 v223, v223, v11
  v_mul_f32 v224, v224, v11
  v_mul_f32 v225, v225, v11
  v_mul_f32 v226, v226, v11
  v_mul_f32 v227, v227, v11
  v_mul_f32 v228, v228, v11
  v_mul_f32 v229, v229, v11
  v_mul_f32 v230, v230, v11
  v_mul_f32 v231, v231, v11
  v_mul_f32 v232, v232, v11
  v_mul_f32 v233, v233, v11
  v_mul_f32 v234, v234, v11
  v_mul_f32 v235, v235, v11
  v_mul_f32 v236, v236, v11
  v_mul_f32 v237, v237, v11
  v_mul_f32 v238, v238, v11
  v_mul_f32 v239, v239, v11
  v_mul_f32 v240, v240, v11
  v_mul_f32 v241, v241, v11
  v_mul_f32 v242, v242, v11
  v_mul_f32 v243, v243, v11
  v_mul_f32 v244, v244, v11
  v_mul_f32 v245, v245, v11
  v_mul_f32 v246, v246, v11
  v_mul_f32 v247, v247, v11
  v_mul_f32 v248, v248, v11
  v_mul_f32 v249, v249, v11
  v_mul_f32 v250, v250, v11
  v_mul_f32 v251, v251, v11
  v_mul_f32 v252, v252, v11
  v_mul_f32 v253, v253, v11
  v_mul_f32 v254, v254, v11
  v_mul_f32 v255, v255, v11
  v_exp_f32 v80, v80
  v_exp_f32 v81, v81
  v_exp_f32 v82, v82
  v_exp_f32 v83, v83
  v_exp_f32 v84, v84
  v_exp_f32 v85, v85
  v_exp_f32 v86, v86
  v_exp_f32 v87, v87
  v_exp_f32 v88, v88
  v_exp_f32 v89, v89
  v_exp_f32 v90, v90
  v_exp_f32 v91, v91
  v_exp_f32 v92, v92
  v_exp_f32 v93, v93
  v_exp_f32 v94, v94
  v_exp_f32 v95, v95
  s_nop 0
  v_add_f32 v9, v80, v81
  v_add_f32 v9, v9, v82
  v_add_f32 v9, v9, v83
  v_add_f32 v9, v9, v84
  v_add_f32 v9, v9, v85
  v_add_f32 v9, v9, v86
  v_add_f32 v9, v9, v87
  v_add_f32 v9, v9, v88
  v_add_f32 v9, v9, v89
  v_add_f32 v9, v9, v90
  v_add_f32 v9, v9, v91
  v_add_f32 v9, v9, v92
  v_add_f32 v9, v9, v93
  v_add_f32 v9, v9, v94
  v_add_f32 v9, v9, v95
  v_cvt_pk_bf16_f32 v40, v80, v81
  v_cvt_pk_bf16_f32 v41, v82, v83
  v_cvt_pk_bf16_f32 v42, v84, v85
  v_cvt_pk_bf16_f32 v43, v86, v87
  v_cvt_pk_bf16_f32 v44, v88, v89
  v_cvt_pk_bf16_f32 v45, v90, v91
  v_cvt_pk_bf16_f32 v46, v92, v93
  v_cvt_pk_bf16_f32 v47, v94, v95
  s_branch RETR_0
RARES_1:
  v_max3_f32 v10, v96, v97, v98
  v_max3_f32 v11, v99, v100, v101
  v_max3_f32 v10, v10, v102, v103
  v_max3_f32 v11, v11, v104, v105
  v_max3_f32 v10, v10, v106, v107
  v_max3_f32 v11, v11, v108, v109
  v_max3_f32 v10, v10, v110, v111
  v_max_f32 v10, v10, v11
  v_mov_b32 v12, v10
  s_nop 1
  v_permlane32_swap_b32 v10, v12
  v_max3_f32 v10, v10, v12, 0
  v_add_f32 v7, v7, v10
  v_exp_f32 v11, -v10
  v_sub_f32 v96, v96, v10
  v_sub_f32 v97, v97, v10
  v_sub_f32 v98, v98, v10
  v_sub_f32 v99, v99, v10
  v_sub_f32 v100, v100, v10
  v_sub_f32 v101, v101, v10
  v_sub_f32 v102, v102, v10
  v_sub_f32 v103, v103, v10
  v_sub_f32 v104, v104, v10
  v_sub_f32 v105, v105, v10
  v_sub_f32 v106, v106, v10
  v_sub_f32 v107, v107, v10
  v_sub_f32 v108, v108, v10
  v_sub_f32 v109, v109, v10
  v_sub_f32 v110, v110, v10
  v_sub_f32 v111, v111, v10
  v_mul_f32 v8, v8, v11
  v_mul_f32 v160, v160, v11
  v_mul_f32 v161, v161, v11
  v_mul_f32 v162, v162, v11
  v_mul_f32 v163, v163, v11
  v_mul_f32 v164, v164, v11
  v_mul_f32 v165, v165, v11
  v_mul_f32 v166, v166, v11
  v_mul_f32 v167, v167, v11
  v_mul_f32 v168, v168, v11
  v_mul_f32 v169, v169, v11
  v_mul_f32 v170, v170, v11
  v_mul_f32 v171, v171, v11
  v_mul_f32 v172, v172, v11
  v_mul_f32 v173, v173, v11
  v_mul_f32 v174, v174, v11
  v_mul_f32 v175, v175, v11
  v_mul_f32 v176, v176, v11
  v_mul_f32 v177, v177, v11
  v_mul_f32 v178, v178, v11
  v_mul_f32 v179, v179, v11
  v_mul_f32 v180, v180, v11
  v_mul_f32 v181, v181, v11
  v_mul_f32 v182, v182, v11
  v_mul_f32 v183, v183, v11
  v_mul_f32 v184, v184, v11
  v_mul_f32 v185, v185, v11
  v_mul_f32 v186, v186, v11
  v_mul_f32 v187, v187, v11
  v_mul_f32 v188, v188, v11
  v_mul_f32 v189, v189, v11
  v_mul_f32 v190, v190, v11
  v_mul_f32 v191, v191, v11
  v_mul_f32 v192, v192, v11
  v_mul_f32 v193, v193, v11
  v_mul_f32 v194, v194, v11
  v_mul_f32 v195, v195, v11
  v_mul_f32 v196, v196, v11
  v_mul_f32 v197, v197, v11
  v_mul_f32 v198, v198, v11
  v_mul_f32 v199, v199, v11
  v_mul_f32 v200, v200, v11
  v_mul_f32 v201, v201, v11
  v_mul_f32 v202, v202, v11
  v_mul_f32 v203, v203, v11
  v_mul_f32 v204, v204, v11
  v_mul_f32 v205, v205, v11
  v_mul_f32 v206, v206, v11
  v_mul_f32 v207, v207, v11
  v_mul_f32 v208, v208, v11
  v_mul_f32 v209, v209, v11
  v_mul_f32 v210, v210, v11
  v_mul_f32 v211, v211, v11
  v_mul_f32 v212, v212, v11
  v_mul_f32 v213, v213, v11
  v_mul_f32 v214, v214, v11
  v_mul_f32 v215, v215, v11
  v_mul_f32 v216, v216, v11
  v_mul_f32 v217, v217, v11
  v_mul_f32 v218, v218, v11
  v_mul_f32 v219, v219, v11
  v_mul_f32 v220, v220, v11
  v_mul_f32 v221, v221, v11
  v_mul_f32 v222, v222, v11
  v_mul_f32 v223, v223, v11
  v_mul_f32 v224, v224, v11
  v_mul_f32 v225, v225, v11
  v_mul_f32 v226, v226, v11
  v_mul_f32 v227, v227, v11
  v_mul_f32 v228, v228, v11
  v_mul_f32 v229, v229, v11
  v_mul_f32 v230, v230, v11
  v_mul_f32 v231, v231, v11
  v_mul_f32 v232, v232, v11
  v_mul_f32 v233, v233, v11
  v_mul_f32 v234, v234, v11
  v_mul_f32 v235, v235, v11
  v_mul_f32 v236, v236, v11
  v_mul_f32 v237, v237, v11
  v_mul_f32 v238, v238, v11
  v_mul_f32 v239, v239, v11
  v_mul_f32 v240, v240, v11
  v_mul_f32 v241, v241, v11
  v_mul_f32 v242, v242, v11
  v_mul_f32 v243, v243, v11
  v_mul_f32 v244, v244, v11
  v_mul_f32 v245, v245, v11
  v_mul_f32 v246, v246, v11
  v_mul_f32 v247, v247, v11
  v_mul_f32 v248, v248, v11
  v_mul_f32 v249, v249, v11
  v_mul_f32 v250, v250, v11
  v_mul_f32 v251, v251, v11
  v_mul_f32 v252, v252, v11
  v_mul_f32 v253, v253, v11
  v_mul_f32 v254, v254, v11
  v_mul_f32 v255, v255, v11
  v_exp_f32 v96, v96
  v_exp_f32 v97, v97
  v_exp_f32 v98, v98
  v_exp_f32 v99, v99
  v_exp_f32 v100, v100
  v_exp_f32 v101, v101
  v_exp_f32 v102, v102
  v_exp_f32 v103, v103
  v_exp_f32 v104, v104
  v_exp_f32 v105, v105
  v_exp_f32 v106, v106
  v_exp_f32 v107, v107
  v_exp_f32 v108, v108
  v_exp_f32 v109, v109
  v_exp_f32 v110, v110
  v_exp_f32 v111, v111
  s_nop 0
  v_add_f32 v9, v96, v97
  v_add_f32 v9, v9, v98
  v_add_f32 v9, v9, v99
  v_add_f32 v9, v9, v100
  v_add_f32 v9, v9, v101
  v_add_f32 v9, v9, v102
  v_add_f32 v9, v9, v103
  v_add_f32 v9, v9, v104
  v_add_f32 v9, v9, v105
  v_add_f32 v9, v9, v106
  v_add_f32 v9, v9, v107
  v_add_f32 v9, v9, v108
  v_add_f32 v9, v9, v109
  v_add_f32 v9, v9, v110
  v_add_f32 v9, v9, v111
  v_cvt_pk_bf16_f32 v40, v96, v97
  v_cvt_pk_bf16_f32 v41, v98, v99
  v_cvt_pk_bf16_f32 v42, v100, v101
  v_cvt_pk_bf16_f32 v43, v102, v103
  v_cvt_pk_bf16_f32 v44, v104, v105
  v_cvt_pk_bf16_f32 v45, v106, v107
  v_cvt_pk_bf16_f32 v46, v108, v109
  v_cvt_pk_bf16_f32 v47, v110, v111
  s_branch RETR_1
RAREF_0:
  v_max3_f32 v10, v80, v81, v82
  v_max3_f32 v11, v83, v84, v85
  v_max3_f32 v10, v10, v86, v87
  v_max3_f32 v11, v11, v88, v89
  v_max3_f32 v10, v10, v90, v91
  v_max3_f32 v11, v11, v92, v93
  v_max3_f32 v10, v10, v94, v95
  v_max_f32 v10, v10, v11
  v_mov_b32 v12, v10
  s_nop 1
  v_permlane32_swap_b32 v10, v12
  v_max_f32 v7, v10, v12
  v_sub_f32 v80, v80, v7
  v_sub_f32 v81, v81, v7
  v_sub_f32 v82, v82, v7
  v_sub_f32 v83, v83, v7
  v_sub_f32 v84, v84, v7
  v_sub_f32 v85, v85, v7
  v_sub_f32 v86, v86, v7
  v_sub_f32 v87, v87, v7
  v_sub_f32 v88, v88, v7
  v_sub_f32 v89, v89, v7
  v_sub_f32 v90, v90, v7
  v_sub_f32 v91, v91, v7
  v_sub_f32 v92, v92, v7
  v_sub_f32 v93, v93, v7
  v_sub_f32 v94, v94, v7
  v_sub_f32 v95, v95, v7
  v_exp_f32 v80, v80
  v_exp_f32 v81, v81
  v_exp_f32 v82, v82
  v_exp_f32 v83, v83
  v_exp_f32 v84, v84
  v_exp_f32 v85, v85
  v_exp_f32 v86, v86
  v_exp_f32 v87, v87
  v_exp_f32 v88, v88
  v_exp_f32 v89, v89
  v_exp_f32 v90, v90
  v_exp_f32 v91, v91
  v_exp_f32 v92, v92
  v_exp_f32 v93, v93
  v_exp_f32 v94, v94
  v_exp_f32 v95, v95
  s_nop 0
  v_add_f32 v9, v80, v81
  v_add_f32 v9, v9, v82
  v_add_f32 v9, v9, v83
  v_add_f32 v9, v9, v84
  v_add_f32 v9, v9, v85
  v_add_f32 v9, v9, v86
  v_add_f32 v9, v9, v87
  v_add_f32 v9, v9, v88
  v_add_f32 v9, v9, v89
  v_add_f32 v9, v9, v90
  v_add_f32 v9, v9, v91
  v_add_f32 v9, v9, v92
  v_add_f32 v9, v9, v93
  v_add_f32 v9, v9, v94
  v_add_f32 v9, v9, v95
  v_cvt_pk_bf16_f32 v40, v80, v81
  v_cvt_pk_bf16_f32 v41, v82, v83
  v_cvt_pk_bf16_f32 v42, v84, v85
  v_cvt_pk_bf16_f32 v43, v86, v87
  v_cvt_pk_bf16_f32 v44, v88, v89
  v_cvt_pk_bf16_f32 v45, v90, v91
  v_cvt_pk_bf16_f32 v46, v92, v93
  v_cvt_pk_bf16_f32 v47, v94, v95
  s_branch RETF
L_CODE_END:

.section .rodata,"a"
.p2align 6
.amdhsa_kernel standalone__ragged_sequences_varlen_flash_attn__ragged_kernel
  .amdhsa_next_free_vgpr 256
  .amdhsa_next_free_sgpr 102
  .amdhsa_accum_offset 256
  .amdhsa_group_segment_fixed_size 0
  .amdhsa_kernarg_size 56
  .amdhsa_user_sgpr_count 2
  .amdhsa_user_sgpr_kernarg_segment_ptr 1
  .amdhsa_system_sgpr_workgroup_id_x 1
.end_amdhsa_kernel
```
